```python
import torch

def _softmax(x, axis=-1):
    return torch.softmax(x, dim=axis)
def _gelu(x):
    return torch.nn.functional.gelu(x, approximate="tanh")
def _silu(x):
    return torch.nn.functional.silu(x)
def _sigmoid(x):
    return torch.sigmoid(x)
def _layernorm(x, axis=-1, eps=1e-5):
    m = x.mean(dim=axis, keepdim=True)
    v = x.var(dim=axis, keepdim=True, unbiased=False)
    return (x - m) / torch.sqrt(v + eps)
def _scatter_add(tgt, idx, src, axis=0):
    return tgt.clone().index_add_(axis, idx, src)
def _segment_sum(src, seg, n):
    out = torch.zeros((n,) + src.shape[1:], dtype=src.dtype)
    return out.index_add_(0, seg, src)
def _pad(x, pw):
    flat = tuple(v for pair in reversed(pw) for v in pair)
    return torch.nn.functional.pad(x, flat)

kernel_name = 'parallel_sum__sliding_block_cached__swiglu_ffn__decode'

def setup_inputs():

    _w = (lambda a: (lambda t: t.to(torch.bfloat16) if t.is_floating_point() else t)(torch.as_tensor(a)))
    def _A_setup():
        B, Sq, D = 1, 1, 1024
        Hq, Hkv, Sk, Dh = 32, 4, 32768, 128
        assert Hq % Hkv == 0, (Hq, Hkv)
        return {
            "x": _w((lambda *s: torch.randn(*s, dtype=torch.bfloat16) * 0.05)(B, Sq, D)),
            "k_cache": _w((lambda *s: torch.randn(*s, dtype=torch.bfloat16) * 3.2)(B, Hkv, Sk, Dh)),
            "v_cache": _w((lambda *s: torch.randn(*s, dtype=torch.bfloat16) * 1.6)(B, Hkv, Sk, Dh)),
            "wq": _w((lambda *s: torch.randn(*s, dtype=torch.bfloat16) * 3.2)(D, Hq * Dh) * (D ** -0.5)),
            "wo": _w((lambda *s: torch.randn(*s, dtype=torch.bfloat16) * 1.6)(Hq * Dh, D) * ((Hq * Dh) ** -0.5)),
        }
    _A_in = _A_setup()

    def _B_setup():
        B, S, D, F = 1, 1, 1024, 3584
        return {
            "x": _w((lambda *s: torch.randn(*s, dtype=torch.bfloat16) * 0.05)(B, S, D)),
            "w_gate": _w((lambda *s: torch.randn(*s, dtype=torch.bfloat16) * 0.05)(D, F)),
            "w_up": _w((lambda *s: torch.randn(*s, dtype=torch.bfloat16) * 0.05)(D, F)),
            "w_down": _w((lambda *s: torch.randn(*s, dtype=torch.bfloat16) * 0.05)(F, D)),
        }
    _B_in = _B_setup()

    return {
        "A_x": _A_in["x"],
        "A_k_cache": _A_in["k_cache"],
        "A_v_cache": _A_in["v_cache"],
        "A_wq": _A_in["wq"],
        "A_wo": _A_in["wo"],
        "B_x": _B_in["x"],
        "B_w_gate": _B_in["w_gate"],
        "B_w_up": _B_in["w_up"],
        "B_w_down": _B_in["w_down"],
    }

def reference(A_x, A_k_cache, A_v_cache, A_wq, A_wo, B_x, B_w_gate, B_w_up, B_w_down):
    def _A_ref(x, k_cache, v_cache, wq, wo):
        B, Sq, D = x.shape
        Hq, Dh = 32, 128
        Hkv, Sk = k_cache.shape[1], k_cache.shape[2]
        W = min(4096, max(256, Sk // 4))
        rep = Hq // Hkv
        q = (lambda x, *d: x.permute(*d))((x @ wq).reshape(B, Sq, Hq, Dh), 0, 2, 1, 3)
        k = (lambda x, n, axis: torch.repeat_interleave(x, n, dim=axis))(k_cache[:, :, Sk - W:, :], rep, axis=1)
        v = (lambda x, n, axis: torch.repeat_interleave(x, n, dim=axis))(v_cache[:, :, Sk - W:, :], rep, axis=1)
        scores = torch.einsum("bhqd,bhkd->bhqk", q, k) * (Dh ** -0.5)
        p = _softmax(scores, axis=-1)
        o = torch.einsum("bhqk,bhkd->bhqd", p, v)
        return (lambda x, *d: x.permute(*d))(o, 0, 2, 1, 3).reshape(B, Sq, Hq * Dh) @ wo

    def _B_ref(x, w_gate, w_up, w_down):
        g = _silu(x @ w_gate)
        u = x @ w_up
        return (g * u) @ w_down

    x = A_x
    xn = _layernorm(x, axis=-1)
    return x + _A_ref(xn, A_k_cache, A_v_cache, A_wq, A_wo) + _B_ref(xn, B_w_gate, B_w_up, B_w_down)
```

```asm
; @launch grid=(256,1,1) block=(768,1,1) lds=82944
.amdgcn_target "amdgcn-amd-amdhsa--gfx950"
.text
.globl parallel_sum__sliding_block_cached__swiglu_ffn__decode_kernel
.p2align 8
.type parallel_sum__sliding_block_cached__swiglu_ffn__decode_kernel,@function
parallel_sum__sliding_block_cached__swiglu_ffn__decode_kernel:
s_cmp_ge_u32 s2, 256
s_cbranch_scc1 L_end
s_load_dwordx16 s[4:19], s[0:1], 0
s_load_dwordx8 s[20:27], s[0:1], 64
v_lshrrev_b32 v1, 6, v0
v_and_b32 v0, 63, v0
v_readfirstlane_b32 s3, v1
v_mov_b32 v7, 0
v_mov_b32 v15, 1
s_add_u32 s3, s3, 12
s_and_b32 s3, s3, 15
s_and_b32 s28, s2, 7
s_lshr_b32 s29, s2, 3
s_lshr_b32 s30, s2, 4
s_and_b32 s44, s3, 3
v_lshrrev_b32 v2, 3, v0
v_and_b32 v3, 7, v0
s_mov_b32 s35, 0x20000
s_mov_b32 s43, 0x20000
s_cmp_lt_u32 s3, 4
s_cbranch_scc1 L_S
s_cmp_eq_u32 s3, 12
s_cbranch_scc1 L_x
s_cmp_lg_u32 s3, 13
s_cbranch_scc1 L_other
s_getpc_b64 s[40:41]
L_pc:
s_mov_b32 s42, L_code_end-L_pc
v_lshlrev_b32 v4, 7, v0
s_lshl_b32 s46, s29, 9
s_mov_b64 exec, 255
buffer_load_dword v40, v4, s[40:43], s46 offen
s_mov_b64 exec, -1
s_branch L_other
L_x:
s_setprio 3
v_lshlrev_b32 v5, 5, v0
s_movk_i32 s42, 2048
s_waitcnt lgkmcnt(0)
s_mov_b32 s40, s4
s_mov_b32 s41, s5
buffer_load_dwordx4 v[16:19], v5, s[40:43], 0 offen
buffer_load_dwordx4 v[20:23], v5, s[40:43], 0 offen offset:16
s_branch L_ln
L_S:
s_setprio 3
s_and_b32 s45, s29, 3
s_lshl_b32 s48, s45, 2
s_add_u32 s48, s48, s44
s_lshr_b32 s47, s29, 2
s_lshr_b32 s46, s29, 4
s_lshl_b32 s46, s46, 2
s_add_u32 s45, s45, s46
s_lshl_b32 s45, s45, 1
s_and_b32 s46, s44, 1
s_add_u32 s45, s45, s46
s_lshl_b32 s46, s44, 1
s_or_b32 s46, s46, 3
s_and_b32 s49, s47, 3
s_cmp_eq_u32 s49, 3
s_cselect_b32 s48, s45, s48
s_cselect_b32 s47, s46, s47
s_lshl_b32 s48, s48, 6
s_lshl_b32 s46, s28, 3
s_add_u32 s47, s47, s46
s_lshl_b32 s47, s47, 7
s_lshl_b32 s46, s48, 13
s_add_u32 s60, s47, s46
s_mov_b32 s38, 0x800000
s_mov_b32 s39, 0x20000
v_lshlrev_b32 v4, 16, v2
v_lshl_add_u32 v4, v3, 4, v4
s_waitcnt lgkmcnt(0)
s_mov_b32 s36, s10
s_mov_b32 s37, s11
buffer_load_dwordx4 v[52:55], v4, s[36:39], s60 offen nt
s_add_u32 s60, s60, 0x2000
buffer_load_dwordx4 v[56:59], v4, s[36:39], s60 offen nt
s_add_u32 s60, s60, 0x2000
buffer_load_dwordx4 v[60:63], v4, s[36:39], s60 offen nt
s_add_u32 s60, s60, 0x2000
buffer_load_dwordx4 v[64:67], v4, s[36:39], s60 offen nt
s_add_u32 s60, s60, 0x2000
buffer_load_dwordx4 v[68:71], v4, s[36:39], s60 offen nt
s_add_u32 s60, s60, 0x2000
buffer_load_dwordx4 v[72:75], v4, s[36:39], s60 offen nt
s_add_u32 s60, s60, 0x2000
buffer_load_dwordx4 v[76:79], v4, s[36:39], s60 offen nt
s_add_u32 s60, s60, 0x2000
buffer_load_dwordx4 v[80:83], v4, s[36:39], s60 offen nt
s_lshr_b32 s46, s30, 1
s_add_u32 s47, s46, 1
s_cmp_eq_u32 s47, 7
s_cselect_b32 s47, 0, s47
s_cmp_ge_u32 s44, 2
s_cselect_b32 s46, s47, s46
s_cselect_b32 s32, s18, s16
s_cselect_b32 s33, s19, s17
s_mul_i32 s47, s28, 7
s_add_u32 s46, s46, s47
s_lshl_b32 s49, s46, 7
s_cmp_ge_u32 s30, 14
s_cselect_b32 s34, 0, 0x700000
s_and_b32 s45, s30, 1
s_lshl_b32 s45, s45, 1
s_and_b32 s46, s44, 1
s_add_u32 s45, s45, s46
s_lshl_b32 s56, s28, 2
s_lshr_b32 s46, s30, 2
s_add_u32 s56, s56, s46
s_and_b32 s46, s30, 3
s_lshl_b32 s57, s46, 9
s_lshl_b32 s46, s44, 7
s_add_u32 s57, s57, s46
s_bitcmp1_b32 s29, 0
s_cbranch_scc1 L_SY
s_mul_i32 s59, s45, 176
s_mul_i32 s47, s59, 7168
s_add_u32 s47, s47, s49
s_mov_b32 s40, s12
s_mov_b32 s41, s13
s_mov_b32 s42, 0x800000
s_lshl_b32 s58, s56, 18
s_add_u32 s58, s58, s57
v_lshlrev_b32 v6, 15, v2
v_lshl_add_u32 v6, v3, 4, v6
v_and_b32 v16, 1, v3
v_cmp_eq_u32 vcc, 1, v16
v_mov_b32 v16, 0x0c0c0100
v_mov_b32 v17, 0x01000c0c
v_cndmask_b32 v16, v16, v17, vcc
v_mov_b32 v17, 0x0c0c0302
v_mov_b32 v18, 0x03020c0c
v_cndmask_b32 v17, v17, v18, vcc
v_lshrrev_b32 v18, 1, v3
v_mov_b32 v19, 0x0c0c0c0c
v_cmp_eq_u32 vcc, 0, v18
s_nop 1
v_cndmask_b32 v32, v19, v16, vcc
v_cndmask_b32 v33, v19, v17, vcc
v_cmp_eq_u32 vcc, 1, v18
s_nop 1
v_cndmask_b32 v34, v19, v16, vcc
v_cndmask_b32 v35, v19, v17, vcc
v_cmp_eq_u32 vcc, 2, v18
s_nop 1
v_cndmask_b32 v36, v19, v16, vcc
v_cndmask_b32 v37, v19, v17, vcc
v_cmp_eq_u32 vcc, 3, v18
s_nop 1
v_cndmask_b32 v38, v19, v16, vcc
v_cndmask_b32 v39, v19, v17, vcc
v_bfe_u32 v16, v0, 4, 1
v_lshl_add_u32 v16, v3, 1, v16
v_lshrrev_b32 v1, 5, v0
v_lshlrev_b32 v1, 8, v1
v_lshl_add_u32 v1, v16, 4, v1
s_lshl_b32 s46, s44, 9
v_add_u32 v1, s46, v1
s_lshl_b32 s48, s48, 1
s_lshl_b32 s59, s59, 1
s_add_u32 s59, s59, 1024
v_lshlrev_b32 v40, 4, v2
v_mul_u32_u24 v41, 44, v2
v_add_u32 v41, s59, v41
v_add_u32 v40, s48, v40
v_mul_u32_u24 v5, 157696, v2
v_lshl_add_u32 v5, v3, 4, v5
s_barrier
ds_read_b128 v[16:19], v40 offset:1024
ds_read2_b32 v[20:21], v41 offset0:0 offset1:1
ds_read2_b32 v[22:23], v41 offset0:2 offset1:3
ds_read2_b32 v[24:25], v41 offset0:4 offset1:5
ds_read2_b32 v[26:27], v41 offset0:6 offset1:7
ds_read2_b32 v[28:29], v41 offset0:8 offset1:9
ds_read2_b32 v[30:31], v41 offset0:10 offset1:11
s_waitcnt lgkmcnt(0)
s_waitcnt vmcnt(7)
v_perm_b32 v40, v16, v16, v32
v_perm_b32 v41, v16, v16, v34
v_perm_b32 v42, v16, v16, v36
v_perm_b32 v43, v16, v16, v38
s_nop 1
v_mfma_f32_16x16x32_bf16 v[48:51], v[40:43], v[52:55], 0
s_waitcnt vmcnt(6)
v_perm_b32 v44, v16, v16, v33
v_perm_b32 v45, v16, v16, v35
v_perm_b32 v46, v16, v16, v37
v_perm_b32 v47, v16, v16, v39
s_nop 1
v_mfma_f32_16x16x32_bf16 v[48:51], v[44:47], v[56:59], v[48:51]
s_waitcnt vmcnt(5)
v_perm_b32 v40, v17, v17, v32
v_perm_b32 v41, v17, v17, v34
v_perm_b32 v42, v17, v17, v36
v_perm_b32 v43, v17, v17, v38
s_nop 1
v_mfma_f32_16x16x32_bf16 v[48:51], v[40:43], v[60:63], v[48:51]
s_waitcnt vmcnt(4)
buffer_load_dwordx4 v[84:87], v5, s[32:35], s47 offen nt
s_add_u32 s47, s47, 7168
v_perm_b32 v44, v17, v17, v33
v_perm_b32 v45, v17, v17, v35
v_perm_b32 v46, v17, v17, v37
v_perm_b32 v47, v17, v17, v39
s_nop 1
v_mfma_f32_16x16x32_bf16 v[48:51], v[44:47], v[64:67], v[48:51]
s_waitcnt vmcnt(4)
buffer_load_dwordx4 v[88:91], v5, s[32:35], s47 offen nt
s_add_u32 s47, s47, 7168
v_perm_b32 v40, v18, v18, v32
v_perm_b32 v41, v18, v18, v34
v_perm_b32 v42, v18, v18, v36
v_perm_b32 v43, v18, v18, v38
s_nop 1
v_mfma_f32_16x16x32_bf16 v[48:51], v[40:43], v[68:71], v[48:51]
s_waitcnt vmcnt(4)
buffer_load_dwordx4 v[92:95], v5, s[32:35], s47 offen nt
s_add_u32 s47, s47, 7168
v_perm_b32 v44, v18, v18, v33
v_perm_b32 v45, v18, v18, v35
v_perm_b32 v46, v18, v18, v37
v_perm_b32 v47, v18, v18, v39
s_nop 1
v_mfma_f32_16x16x32_bf16 v[48:51], v[44:47], v[72:75], v[48:51]
s_waitcnt vmcnt(4)
buffer_load_dwordx4 v[96:99], v5, s[32:35], s47 offen nt
s_add_u32 s47, s47, 7168
v_perm_b32 v40, v19, v19, v32
v_perm_b32 v41, v19, v19, v34
v_perm_b32 v42, v19, v19, v36
v_perm_b32 v43, v19, v19, v38
s_nop 1
v_mfma_f32_16x16x32_bf16 v[48:51], v[40:43], v[76:79], v[48:51]
s_waitcnt vmcnt(4)
buffer_load_dwordx4 v[100:103], v5, s[32:35], s47 offen nt
s_add_u32 s47, s47, 7168
v_perm_b32 v44, v19, v19, v33
v_perm_b32 v45, v19, v19, v35
v_perm_b32 v46, v19, v19, v37
v_perm_b32 v47, v19, v19, v39
s_nop 1
v_mfma_f32_16x16x32_bf16 v[48:51], v[44:47], v[80:83], v[48:51]
s_mov_b32 exec_lo, 0x00ff00ff
s_mov_b32 exec_hi, 0xff00ff00
s_nop 5
ds_write_b128 v1, v[48:51] offset:3584
s_mov_b64 exec, 1
ds_add_u32 v7, v15 offset:8
s_mov_b64 exec, -1
s_waitcnt vmcnt(4)
buffer_load_dwordx4 v[104:107], v5, s[32:35], s47 offen nt
s_add_u32 s47, s47, 7168
v_perm_b32 v40, v20, v20, v32
v_perm_b32 v41, v20, v20, v34
v_perm_b32 v42, v20, v20, v36
v_perm_b32 v43, v20, v20, v38
s_nop 1
v_mfma_f32_16x16x32_bf16 v[48:51], v[40:43], v[84:87], 0
s_waitcnt vmcnt(4)
buffer_load_dwordx4 v[108:111], v5, s[32:35], s47 offen nt
s_add_u32 s47, s47, 7168
v_perm_b32 v44, v20, v20, v33
v_perm_b32 v45, v20, v20, v35
v_perm_b32 v46, v20, v20, v37
v_perm_b32 v47, v20, v20, v39
s_nop 1
v_mfma_f32_16x16x32_bf16 v[48:51], v[44:47], v[88:91], v[48:51]
s_waitcnt vmcnt(4)
buffer_load_dwordx4 v[112:115], v5, s[32:35], s47 offen nt
s_add_u32 s47, s47, 7168
v_perm_b32 v40, v21, v21, v32
v_perm_b32 v41, v21, v21, v34
v_perm_b32 v42, v21, v21, v36
v_perm_b32 v43, v21, v21, v38
s_nop 1
v_mfma_f32_16x16x32_bf16 v[48:51], v[40:43], v[92:95], v[48:51]
s_waitcnt vmcnt(4)
buffer_load_dwordx4 v[84:87], v5, s[32:35], s47 offen nt
s_add_u32 s47, s47, 7168
v_perm_b32 v44, v21, v21, v33
v_perm_b32 v45, v21, v21, v35
v_perm_b32 v46, v21, v21, v37
v_perm_b32 v47, v21, v21, v39
s_nop 1
v_mfma_f32_16x16x32_bf16 v[48:51], v[44:47], v[96:99], v[48:51]
s_waitcnt vmcnt(4)
buffer_load_dwordx4 v[88:91], v5, s[32:35], s47 offen nt
s_add_u32 s47, s47, 7168
v_perm_b32 v40, v22, v22, v32
v_perm_b32 v41, v22, v22, v34
v_perm_b32 v42, v22, v22, v36
v_perm_b32 v43, v22, v22, v38
s_nop 1
v_mfma_f32_16x16x32_bf16 v[48:51], v[40:43], v[100:103], v[48:51]
s_waitcnt vmcnt(4)
buffer_load_dwordx4 v[92:95], v5, s[32:35], s47 offen nt
s_add_u32 s47, s47, 7168
v_perm_b32 v44, v22, v22, v33
v_perm_b32 v45, v22, v22, v35
v_perm_b32 v46, v22, v22, v37
v_perm_b32 v47, v22, v22, v39
s_nop 1
v_mfma_f32_16x16x32_bf16 v[48:51], v[44:47], v[104:107], v[48:51]
s_waitcnt vmcnt(4)
buffer_load_dwordx4 v[96:99], v5, s[32:35], s47 offen nt
s_add_u32 s47, s47, 7168
v_perm_b32 v40, v23, v23, v32
v_perm_b32 v41, v23, v23, v34
v_perm_b32 v42, v23, v23, v36
v_perm_b32 v43, v23, v23, v38
s_nop 1
v_mfma_f32_16x16x32_bf16 v[48:51], v[40:43], v[108:111], v[48:51]
s_waitcnt vmcnt(4)
buffer_load_dwordx4 v[100:103], v5, s[32:35], s47 offen nt
s_add_u32 s47, s47, 7168
v_perm_b32 v44, v23, v23, v33
v_perm_b32 v45, v23, v23, v35
v_perm_b32 v46, v23, v23, v37
v_perm_b32 v47, v23, v23, v39
s_nop 1
v_mfma_f32_16x16x32_bf16 v[48:51], v[44:47], v[112:115], v[48:51]
s_waitcnt vmcnt(4)
buffer_load_dwordx4 v[104:107], v5, s[32:35], s47 offen nt
s_add_u32 s47, s47, 7168
v_perm_b32 v40, v24, v24, v32
v_perm_b32 v41, v24, v24, v34
v_perm_b32 v42, v24, v24, v36
v_perm_b32 v43, v24, v24, v38
s_nop 1
v_mfma_f32_16x16x32_bf16 v[48:51], v[40:43], v[84:87], v[48:51]
s_waitcnt vmcnt(4)
buffer_load_dwordx4 v[108:111], v5, s[32:35], s47 offen nt
s_add_u32 s47, s47, 7168
v_perm_b32 v44, v24, v24, v33
v_perm_b32 v45, v24, v24, v35
v_perm_b32 v46, v24, v24, v37
v_perm_b32 v47, v24, v24, v39
s_nop 1
v_mfma_f32_16x16x32_bf16 v[48:51], v[44:47], v[88:91], v[48:51]
s_waitcnt vmcnt(4)
buffer_load_dwordx4 v[112:115], v5, s[32:35], s47 offen nt
s_add_u32 s47, s47, 7168
v_perm_b32 v40, v25, v25, v32
v_perm_b32 v41, v25, v25, v34
v_perm_b32 v42, v25, v25, v36
v_perm_b32 v43, v25, v25, v38
s_nop 1
v_mfma_f32_16x16x32_bf16 v[48:51], v[40:43], v[92:95], v[48:51]
s_waitcnt vmcnt(4)
buffer_load_dwordx4 v[84:87], v5, s[32:35], s47 offen nt
s_add_u32 s47, s47, 7168
v_perm_b32 v44, v25, v25, v33
v_perm_b32 v45, v25, v25, v35
v_perm_b32 v46, v25, v25, v37
v_perm_b32 v47, v25, v25, v39
s_nop 1
v_mfma_f32_16x16x32_bf16 v[48:51], v[44:47], v[96:99], v[48:51]
s_waitcnt vmcnt(4)
buffer_load_dwordx4 v[88:91], v5, s[32:35], s47 offen nt
s_add_u32 s47, s47, 7168
v_perm_b32 v40, v26, v26, v32
v_perm_b32 v41, v26, v26, v34
v_perm_b32 v42, v26, v26, v36
v_perm_b32 v43, v26, v26, v38
s_nop 1
v_mfma_f32_16x16x32_bf16 v[48:51], v[40:43], v[100:103], v[48:51]
s_waitcnt vmcnt(4)
buffer_load_dwordx4 v[92:95], v5, s[32:35], s47 offen nt
s_add_u32 s47, s47, 7168
v_perm_b32 v44, v26, v26, v33
v_perm_b32 v45, v26, v26, v35
v_perm_b32 v46, v26, v26, v37
v_perm_b32 v47, v26, v26, v39
s_nop 1
v_mfma_f32_16x16x32_bf16 v[48:51], v[44:47], v[104:107], v[48:51]
s_waitcnt vmcnt(4)
buffer_load_dwordx4 v[96:99], v5, s[32:35], s47 offen nt
s_add_u32 s47, s47, 7168
v_perm_b32 v40, v27, v27, v32
v_perm_b32 v41, v27, v27, v34
v_perm_b32 v42, v27, v27, v36
v_perm_b32 v43, v27, v27, v38
s_nop 1
v_mfma_f32_16x16x32_bf16 v[48:51], v[40:43], v[108:111], v[48:51]
s_waitcnt vmcnt(4)
buffer_load_dwordx4 v[100:103], v5, s[32:35], s47 offen nt
s_add_u32 s47, s47, 7168
v_perm_b32 v44, v27, v27, v33
v_perm_b32 v45, v27, v27, v35
v_perm_b32 v46, v27, v27, v37
v_perm_b32 v47, v27, v27, v39
s_nop 1
v_mfma_f32_16x16x32_bf16 v[48:51], v[44:47], v[112:115], v[48:51]
s_waitcnt vmcnt(4)
buffer_load_dwordx4 v[104:107], v5, s[32:35], s47 offen nt
v_perm_b32 v40, v28, v28, v32
v_perm_b32 v41, v28, v28, v34
v_perm_b32 v42, v28, v28, v36
v_perm_b32 v43, v28, v28, v38
s_nop 1
v_mfma_f32_16x16x32_bf16 v[48:51], v[40:43], v[84:87], v[48:51]
s_waitcnt vmcnt(4)
buffer_load_dwordx4 v[52:55], v6, s[40:43], s58 offen offset:0 nt
v_perm_b32 v44, v28, v28, v33
v_perm_b32 v45, v28, v28, v35
v_perm_b32 v46, v28, v28, v37
v_perm_b32 v47, v28, v28, v39
s_nop 1
v_mfma_f32_16x16x32_bf16 v[48:51], v[44:47], v[88:91], v[48:51]
s_waitcnt vmcnt(4)
buffer_load_dwordx4 v[56:59], v6, s[40:43], s58 offen offset:2048 nt
s_add_u32 s58, s58, 4096
v_perm_b32 v40, v29, v29, v32
v_perm_b32 v41, v29, v29, v34
v_perm_b32 v42, v29, v29, v36
v_perm_b32 v43, v29, v29, v38
s_nop 1
v_mfma_f32_16x16x32_bf16 v[48:51], v[40:43], v[92:95], v[48:51]
s_waitcnt vmcnt(4)
buffer_load_dwordx4 v[60:63], v6, s[40:43], s58 offen offset:0 nt
v_perm_b32 v44, v29, v29, v33
v_perm_b32 v45, v29, v29, v35
v_perm_b32 v46, v29, v29, v37
v_perm_b32 v47, v29, v29, v39
s_nop 1
v_mfma_f32_16x16x32_bf16 v[48:51], v[44:47], v[96:99], v[48:51]
s_waitcnt vmcnt(4)
buffer_load_dwordx4 v[64:67], v6, s[40:43], s58 offen offset:2048 nt
s_add_u32 s58, s58, 4096
v_perm_b32 v40, v30, v30, v32
v_perm_b32 v41, v30, v30, v34
v_perm_b32 v42, v30, v30, v36
v_perm_b32 v43, v30, v30, v38
s_nop 1
v_mfma_f32_16x16x32_bf16 v[48:51], v[40:43], v[100:103], v[48:51]
s_waitcnt vmcnt(4)
buffer_load_dwordx4 v[68:71], v6, s[40:43], s58 offen offset:0 nt
v_perm_b32 v44, v30, v30, v33
v_perm_b32 v45, v30, v30, v35
v_perm_b32 v46, v30, v30, v37
v_perm_b32 v47, v30, v30, v39
s_nop 1
v_mfma_f32_16x16x32_bf16 v[48:51], v[44:47], v[104:107], v[48:51]
s_mov_b32 exec_lo, 0x00ff00ff
s_mov_b32 exec_hi, 0xff00ff00
s_nop 5
ds_write_b128 v1, v[48:51] offset:5632
s_mov_b64 exec, 1
ds_add_u32 v7, v15 offset:12
s_mov_b64 exec, -1
s_waitcnt vmcnt(4)
buffer_load_dwordx4 v[72:75], v6, s[40:43], s58 offen offset:2048 nt
s_add_u32 s58, s58, 4096
s_waitcnt vmcnt(4)
buffer_load_dwordx4 v[76:79], v6, s[40:43], s58 offen offset:0 nt
s_waitcnt vmcnt(4)
buffer_load_dwordx4 v[80:83], v6, s[40:43], s58 offen offset:2048 nt
s_add_u32 s58, s58, 4096
s_waitcnt vmcnt(4)
buffer_load_dwordx4 v[84:87], v6, s[40:43], s58 offen offset:0 nt
s_waitcnt vmcnt(4)
buffer_load_dwordx4 v[88:91], v6, s[40:43], s58 offen offset:2048 nt
s_add_u32 s58, s58, 4096
s_waitcnt vmcnt(4)
buffer_load_dwordx4 v[92:95], v6, s[40:43], s58 offen offset:0 nt
s_waitcnt vmcnt(4)
buffer_load_dwordx4 v[96:99], v6, s[40:43], s58 offen offset:2048 nt
s_add_u32 s58, s58, 4096
s_waitcnt vmcnt(4)
buffer_load_dwordx4 v[100:103], v6, s[40:43], s58 offen offset:0 nt
s_waitcnt vmcnt(4)
buffer_load_dwordx4 v[104:107], v6, s[40:43], s58 offen offset:2048 nt
s_add_u32 s58, s58, 4096
s_waitcnt vmcnt(4)
buffer_load_dwordx4 v[108:111], v6, s[40:43], s58 offen offset:0 nt
s_waitcnt vmcnt(4)
buffer_load_dwordx4 v[112:115], v6, s[40:43], s58 offen offset:2048 nt
s_mov_b32 s45, 56
s_mov_b32 s46, 4
s_mov_b32 s49, 0
s_branch L_F
L_SY:
s_lshr_b32 s47, s28, 1
s_lshl_b32 s47, s47, 23
s_and_b32 s46, s28, 1
s_lshl_b32 s46, s46, 4
s_add_u32 s46, s46, s30
s_lshl_b32 s46, s46, 15
s_add_u32 s47, s47, s46
s_lshl_b32 s46, s44, 13
s_add_u32 s58, s47, s46
s_add_u32 s58, s58, 7340032
s_add_u32 s61, s46, 12288
v_lshrrev_b32 v16, 4, v0
v_and_b32 v17, 15, v0
v_xor_b32 v8, v17, v16
v_lshlrev_b32 v8, 4, v8
v_lshl_add_u32 v8, v16, 8, v8
v_xor_b32 v9, 64, v8
v_xor_b32 v10, 128, v8
v_xor_b32 v14, 192, v8
v_lshlrev_b32 v12, 1, v16
v_xor_b32 v12, v17, v12
v_lshlrev_b32 v12, 4, v12
v_lshl_add_u32 v12, v16, 8, v12
v_xor_b32 v13, 128, v12
s_mov_b32 s40, s6
s_mov_b32 s41, s7
s_mov_b32 s42, 0x2000000
s_mul_i32 s59, s45, 80
s_add_u32 s59, s59, 704
s_mul_i32 s47, s59, 7168
s_add_u32 s47, s47, s49
s_lshl_b32 s46, s44, 2
v_mov_b32 v11, s46
v_mul_u32_u24 v6, 28672, v2
v_lshl_add_u32 v6, v3, 4, v6
v_and_b32 v16, 1, v3
v_cmp_eq_u32 vcc, 1, v16
v_mov_b32 v16, 0x0c0c0100
v_mov_b32 v17, 0x01000c0c
v_cndmask_b32 v16, v16, v17, vcc
v_mov_b32 v17, 0x0c0c0302
v_mov_b32 v18, 0x03020c0c
v_cndmask_b32 v17, v17, v18, vcc
v_lshrrev_b32 v18, 1, v3
v_mov_b32 v19, 0x0c0c0c0c
v_cmp_eq_u32 vcc, 0, v18
s_nop 1
v_cndmask_b32 v32, v19, v16, vcc
v_cndmask_b32 v33, v19, v17, vcc
v_cmp_eq_u32 vcc, 1, v18
s_nop 1
v_cndmask_b32 v34, v19, v16, vcc
v_cndmask_b32 v35, v19, v17, vcc
v_cmp_eq_u32 vcc, 2, v18
s_nop 1
v_cndmask_b32 v36, v19, v16, vcc
v_cndmask_b32 v37, v19, v17, vcc
v_cmp_eq_u32 vcc, 3, v18
s_nop 1
v_cndmask_b32 v38, v19, v16, vcc
v_cndmask_b32 v39, v19, v17, vcc
v_bfe_u32 v16, v0, 4, 1
v_lshl_add_u32 v16, v3, 1, v16
v_lshrrev_b32 v1, 5, v0
v_lshlrev_b32 v1, 8, v1
v_lshl_add_u32 v1, v16, 4, v1
s_lshl_b32 s46, s44, 9
v_add_u32 v1, s46, v1
s_lshl_b32 s48, s48, 1
s_lshl_b32 s59, s59, 1
s_add_u32 s59, s59, 1024
v_lshlrev_b32 v40, 4, v2
v_mul_u32_u24 v41, 20, v2
v_add_u32 v41, s59, v41
v_add_u32 v40, s48, v40
v_mul_u32_u24 v5, 71680, v2
v_lshl_add_u32 v5, v3, 4, v5
s_barrier
ds_read_b128 v[16:19], v40 offset:1024
ds_read2_b32 v[20:21], v41 offset0:0 offset1:1
ds_read2_b32 v[22:23], v41 offset0:2 offset1:3
ds_read2_b32 v[24:25], v41 offset0:4 offset1:5
s_waitcnt lgkmcnt(0)
s_waitcnt vmcnt(7)
v_perm_b32 v40, v16, v16, v32
v_perm_b32 v41, v16, v16, v34
v_perm_b32 v42, v16, v16, v36
v_perm_b32 v43, v16, v16, v38
s_nop 1
v_mfma_f32_16x16x32_bf16 v[48:51], v[40:43], v[52:55], 0
s_waitcnt vmcnt(6)
v_perm_b32 v44, v16, v16, v33
v_perm_b32 v45, v16, v16, v35
v_perm_b32 v46, v16, v16, v37
v_perm_b32 v47, v16, v16, v39
s_nop 1
v_mfma_f32_16x16x32_bf16 v[48:51], v[44:47], v[56:59], v[48:51]
s_waitcnt vmcnt(5)
s_add_u32 m0, s61, 0
s_nop 0
buffer_load_dwordx4 v8, s[40:43], s58 offen offset:0 nt lds
v_perm_b32 v40, v17, v17, v32
v_perm_b32 v41, v17, v17, v34
v_perm_b32 v42, v17, v17, v36
v_perm_b32 v43, v17, v17, v38
s_nop 1
v_mfma_f32_16x16x32_bf16 v[48:51], v[40:43], v[60:63], v[48:51]
s_waitcnt vmcnt(5)
buffer_load_dwordx4 v9, s[40:43], s58 offen offset:1024 nt lds
v_perm_b32 v44, v17, v17, v33
v_perm_b32 v45, v17, v17, v35
v_perm_b32 v46, v17, v17, v37
v_perm_b32 v47, v17, v17, v39
s_nop 1
v_mfma_f32_16x16x32_bf16 v[48:51], v[44:47], v[64:67], v[48:51]
s_waitcnt vmcnt(5)
buffer_load_dwordx4 v10, s[40:43], s58 offen offset:2048 nt lds
v_perm_b32 v40, v18, v18, v32
v_perm_b32 v41, v18, v18, v34
v_perm_b32 v42, v18, v18, v36
v_perm_b32 v43, v18, v18, v38
s_nop 1
v_mfma_f32_16x16x32_bf16 v[48:51], v[40:43], v[68:71], v[48:51]
s_waitcnt vmcnt(5)
buffer_load_dwordx4 v14, s[40:43], s58 offen offset:3072 nt lds
v_perm_b32 v44, v18, v18, v33
v_perm_b32 v45, v18, v18, v35
v_perm_b32 v46, v18, v18, v37
v_perm_b32 v47, v18, v18, v39
s_nop 1
v_mfma_f32_16x16x32_bf16 v[48:51], v[44:47], v[72:75], v[48:51]
s_waitcnt vmcnt(5)
s_add_u32 m0, s61, 4096
s_add_u32 s58, s58, 4096
buffer_load_dwordx4 v8, s[40:43], s58 offen offset:0 nt lds
v_perm_b32 v40, v19, v19, v32
v_perm_b32 v41, v19, v19, v34
v_perm_b32 v42, v19, v19, v36
v_perm_b32 v43, v19, v19, v38
s_nop 1
v_mfma_f32_16x16x32_bf16 v[48:51], v[40:43], v[76:79], v[48:51]
s_waitcnt vmcnt(5)
buffer_load_dwordx4 v9, s[40:43], s58 offen offset:1024 nt lds
v_perm_b32 v44, v19, v19, v33
v_perm_b32 v45, v19, v19, v35
v_perm_b32 v46, v19, v19, v37
v_perm_b32 v47, v19, v19, v39
s_nop 1
v_mfma_f32_16x16x32_bf16 v[48:51], v[44:47], v[80:83], v[48:51]
s_mov_b32 exec_lo, 0x00ff00ff
s_mov_b32 exec_hi, 0xff00ff00
s_nop 5
ds_write_b128 v1, v[48:51] offset:3584
s_mov_b64 exec, 1
ds_add_u32 v7, v15 offset:8
s_mov_b64 exec, -1
s_waitcnt vmcnt(5)
buffer_load_dwordx4 v10, s[40:43], s58 offen offset:2048 nt lds
s_waitcnt vmcnt(5)
buffer_load_dwordx4 v14, s[40:43], s58 offen offset:3072 nt lds
s_waitcnt vmcnt(5)
s_mov_b32 s40, s8
s_mov_b32 s41, s9
s_sub_u32 s58, s58, 8192
s_add_u32 m0, s61, 32768
s_add_u32 s58, s58, 4096
buffer_load_dwordx4 v12, s[40:43], s58 offen offset:0 nt lds
s_waitcnt vmcnt(5)
buffer_load_dwordx4 v13, s[40:43], s58 offen offset:1024 nt lds
s_waitcnt vmcnt(5)
buffer_load_dwordx4 v12, s[40:43], s58 offen offset:2048 nt lds
s_waitcnt vmcnt(5)
buffer_load_dwordx4 v13, s[40:43], s58 offen offset:3072 nt lds
s_waitcnt vmcnt(5)
s_add_u32 m0, s61, 36864
s_add_u32 s58, s58, 4096
buffer_load_dwordx4 v12, s[40:43], s58 offen offset:0 nt lds
s_waitcnt vmcnt(5)
buffer_load_dwordx4 v13, s[40:43], s58 offen offset:1024 nt lds
s_mov_b64 exec, 1
ds_add_u32 v11, v15 offset:16
s_mov_b64 exec, -1
s_waitcnt vmcnt(5)
buffer_load_dwordx4 v12, s[40:43], s58 offen offset:2048 nt lds
s_mov_b64 exec, 1
ds_add_u32 v7, v15 offset:68
s_mov_b64 exec, -1
s_waitcnt vmcnt(5)
buffer_load_dwordx4 v13, s[40:43], s58 offen offset:3072 nt lds
s_mov_b32 s40, s20
s_mov_b32 s41, s21
s_mov_b32 s42, 0x700000
s_mul_i32 s58, s56, 229376
s_add_u32 s58, s58, s57
s_waitcnt vmcnt(4)
buffer_load_dwordx4 v[84:87], v5, s[32:35], s47 offen nt
s_add_u32 s47, s47, 7168
s_waitcnt vmcnt(4)
buffer_load_dwordx4 v[88:91], v5, s[32:35], s47 offen nt
s_add_u32 s47, s47, 7168
s_waitcnt vmcnt(4)
buffer_load_dwordx4 v[92:95], v5, s[32:35], s47 offen nt
s_add_u32 s47, s47, 7168
s_waitcnt vmcnt(4)
buffer_load_dwordx4 v[96:99], v5, s[32:35], s47 offen nt
s_add_u32 s47, s47, 7168
s_waitcnt vmcnt(4)
buffer_load_dwordx4 v[100:103], v5, s[32:35], s47 offen nt
s_add_u32 s47, s47, 7168
s_mov_b64 exec, 1
ds_add_u32 v11, v15 offset:32
s_mov_b64 exec, -1
s_waitcnt vmcnt(4)
buffer_load_dwordx4 v[104:107], v5, s[32:35], s47 offen nt
s_add_u32 s47, s47, 7168
v_perm_b32 v40, v20, v20, v32
v_perm_b32 v41, v20, v20, v34
v_perm_b32 v42, v20, v20, v36
v_perm_b32 v43, v20, v20, v38
s_nop 1
v_mfma_f32_16x16x32_bf16 v[48:51], v[40:43], v[84:87], 0
s_waitcnt vmcnt(4)
buffer_load_dwordx4 v[108:111], v5, s[32:35], s47 offen nt
s_add_u32 s47, s47, 7168
v_perm_b32 v44, v20, v20, v33
v_perm_b32 v45, v20, v20, v35
v_perm_b32 v46, v20, v20, v37
v_perm_b32 v47, v20, v20, v39
s_nop 1
v_mfma_f32_16x16x32_bf16 v[48:51], v[44:47], v[88:91], v[48:51]
s_waitcnt vmcnt(4)
buffer_load_dwordx4 v[112:115], v5, s[32:35], s47 offen nt
s_add_u32 s47, s47, 7168
v_perm_b32 v40, v21, v21, v32
v_perm_b32 v41, v21, v21, v34
v_perm_b32 v42, v21, v21, v36
v_perm_b32 v43, v21, v21, v38
s_nop 1
v_mfma_f32_16x16x32_bf16 v[48:51], v[40:43], v[92:95], v[48:51]
s_waitcnt vmcnt(4)
buffer_load_dwordx4 v[84:87], v5, s[32:35], s47 offen nt
s_add_u32 s47, s47, 7168
v_perm_b32 v44, v21, v21, v33
v_perm_b32 v45, v21, v21, v35
v_perm_b32 v46, v21, v21, v37
v_perm_b32 v47, v21, v21, v39
s_nop 1
v_mfma_f32_16x16x32_bf16 v[48:51], v[44:47], v[96:99], v[48:51]
s_waitcnt vmcnt(4)
buffer_load_dwordx4 v[88:91], v5, s[32:35], s47 offen nt
v_perm_b32 v40, v22, v22, v32
v_perm_b32 v41, v22, v22, v34
v_perm_b32 v42, v22, v22, v36
v_perm_b32 v43, v22, v22, v38
s_nop 1
v_mfma_f32_16x16x32_bf16 v[48:51], v[40:43], v[100:103], v[48:51]
s_waitcnt vmcnt(4)
buffer_load_dwordx4 v[60:63], v6, s[40:43], s58 offen offset:0 nt
v_perm_b32 v44, v22, v22, v33
v_perm_b32 v45, v22, v22, v35
v_perm_b32 v46, v22, v22, v37
v_perm_b32 v47, v22, v22, v39
s_nop 1
v_mfma_f32_16x16x32_bf16 v[48:51], v[44:47], v[104:107], v[48:51]
s_waitcnt vmcnt(4)
buffer_load_dwordx4 v[64:67], v6, s[40:43], s58 offen offset:2048 nt
s_add_u32 s58, s58, 4096
v_perm_b32 v40, v23, v23, v32
v_perm_b32 v41, v23, v23, v34
v_perm_b32 v42, v23, v23, v36
v_perm_b32 v43, v23, v23, v38
s_nop 1
v_mfma_f32_16x16x32_bf16 v[48:51], v[40:43], v[108:111], v[48:51]
s_waitcnt vmcnt(4)
buffer_load_dwordx4 v[68:71], v6, s[40:43], s58 offen offset:0 nt
v_perm_b32 v44, v23, v23, v33
v_perm_b32 v45, v23, v23, v35
v_perm_b32 v46, v23, v23, v37
v_perm_b32 v47, v23, v23, v39
s_nop 1
v_mfma_f32_16x16x32_bf16 v[48:51], v[44:47], v[112:115], v[48:51]
s_waitcnt vmcnt(4)
buffer_load_dwordx4 v[72:75], v6, s[40:43], s58 offen offset:2048 nt
s_add_u32 s58, s58, 4096
v_perm_b32 v40, v24, v24, v32
v_perm_b32 v41, v24, v24, v34
v_perm_b32 v42, v24, v24, v36
v_perm_b32 v43, v24, v24, v38
s_nop 1
v_mfma_f32_16x16x32_bf16 v[48:51], v[40:43], v[84:87], v[48:51]
s_waitcnt vmcnt(4)
buffer_load_dwordx4 v[76:79], v6, s[40:43], s58 offen offset:0 nt
v_perm_b32 v44, v24, v24, v33
v_perm_b32 v45, v24, v24, v35
v_perm_b32 v46, v24, v24, v37
v_perm_b32 v47, v24, v24, v39
s_nop 1
v_mfma_f32_16x16x32_bf16 v[48:51], v[44:47], v[88:91], v[48:51]
s_mov_b32 exec_lo, 0x00ff00ff
s_mov_b32 exec_hi, 0xff00ff00
s_nop 5
ds_write_b128 v1, v[48:51] offset:5632
s_mov_b64 exec, 1
ds_add_u32 v7, v15 offset:12
s_mov_b64 exec, -1
s_waitcnt vmcnt(4)
buffer_load_dwordx4 v[80:83], v6, s[40:43], s58 offen offset:2048 nt
s_add_u32 s58, s58, 4096
s_waitcnt vmcnt(4)
buffer_load_dwordx4 v[84:87], v6, s[40:43], s58 offen offset:0 nt
s_waitcnt vmcnt(4)
buffer_load_dwordx4 v[88:91], v6, s[40:43], s58 offen offset:2048 nt
s_add_u32 s58, s58, 4096
s_waitcnt vmcnt(4)
buffer_load_dwordx4 v[92:95], v6, s[40:43], s58 offen offset:0 nt
s_waitcnt vmcnt(4)
buffer_load_dwordx4 v[96:99], v6, s[40:43], s58 offen offset:2048 nt
s_add_u32 s58, s58, 4096
s_waitcnt vmcnt(4)
buffer_load_dwordx4 v[100:103], v6, s[40:43], s58 offen offset:0 nt
s_waitcnt vmcnt(4)
buffer_load_dwordx4 v[104:107], v6, s[40:43], s58 offen offset:2048 nt
s_add_u32 s58, s58, 4096
s_waitcnt vmcnt(4)
buffer_load_dwordx4 v[108:111], v6, s[40:43], s58 offen offset:0 nt
s_waitcnt vmcnt(4)
buffer_load_dwordx4 v[112:115], v6, s[40:43], s58 offen offset:2048 nt
s_mov_b32 s45, 60
s_mov_b32 s46, 1
s_mov_b32 s49, 4096
L_F:
s_lshl_b32 s58, s57, 7
s_lshl_b32 s48, s56, 7
s_add_u32 s58, s58, s48
s_add_u32 s58, s58, s49
s_add_u32 s58, s58, 724992
s_mov_b32 s36, s26
s_mov_b32 s37, s27
s_mov_b32 s38, 0x300000
s_mov_b32 s39, 0x20000
s_mov_b32 s52, 0x7060500
s_mov_b32 s53, 0x7060501
s_mov_b32 s54, 0x7060502
s_mov_b32 s55, 0x7060503
ds_read_b32 v11, v7 offset:4
s_waitcnt lgkmcnt(0)
v_readfirstlane_b32 s31, v11
v_mov_b32 v6, s45
v_lshlrev_b32 v5, 5, v2
v_bfe_u32 v10, v0, 4, 1
v_lshl_add_u32 v12, v3, 1, v10
v_and_b32 v13, 7, v12
v_lshlrev_b32 v13, 4, v13
v_lshrrev_b32 v12, 3, v12
v_lshl_add_u32 v13, v12, 13, v13
v_mov_b32 v48, 0
v_mov_b32 v49, 0
v_mov_b32 v50, 0
v_mov_b32 v51, 0
s_mov_b32 s60, 1600000
L_lw_1:
ds_read_b32 v10, v6 offset:0
ds_read_b128 v[16:19], v5 offset:3072
ds_read_b128 v[20:23], v5 offset:3088
s_waitcnt lgkmcnt(0)
v_readfirstlane_b32 s61, v10
s_nop 0
s_cmp_ge_u32 s61, s46
s_nop 1
s_cbranch_scc1 L_lwd_2
s_sub_u32 s60, s60, 1
s_cmp_lg_u32 s60, 0
s_cbranch_scc1 L_lw_1
L_lwd_2:
s_cmp_lg_u32 s49, 0
s_cbranch_scc1 L_mm2
v_perm_b32 v40, v16, v16, v32
v_perm_b32 v41, v16, v16, v34
v_perm_b32 v42, v16, v16, v36
v_perm_b32 v43, v16, v16, v38
v_perm_b32 v44, v16, v16, v33
v_perm_b32 v45, v16, v16, v35
v_perm_b32 v46, v16, v16, v37
v_perm_b32 v47, v16, v16, v39
v_perm_b32 v24, v17, v17, v32
v_perm_b32 v25, v17, v17, v34
v_perm_b32 v26, v17, v17, v36
v_perm_b32 v27, v17, v17, v38
v_mfma_f32_16x16x32_bf16 v[48:51], v[40:43], v[52:55], v[48:51]
v_perm_b32 v28, v17, v17, v33
v_perm_b32 v29, v17, v17, v35
v_perm_b32 v30, v17, v17, v37
v_perm_b32 v31, v17, v17, v39
v_mfma_f32_16x16x32_bf16 v[48:51], v[44:47], v[56:59], v[48:51]
s_nop 6
s_branch L_mm3
L_mm2:
v_perm_b32 v24, v17, v17, v32
v_perm_b32 v25, v17, v17, v34
v_perm_b32 v26, v17, v17, v36
v_perm_b32 v27, v17, v17, v38
v_perm_b32 v28, v17, v17, v33
v_perm_b32 v29, v17, v17, v35
v_perm_b32 v30, v17, v17, v37
v_perm_b32 v31, v17, v17, v39
L_mm3:
v_perm_b32 v40, v18, v18, v32
v_perm_b32 v41, v18, v18, v34
v_perm_b32 v42, v18, v18, v36
v_perm_b32 v43, v18, v18, v38
v_mfma_f32_16x16x32_bf16 v[48:51], v[24:27], v[60:63], v[48:51]
v_perm_b32 v44, v18, v18, v33
v_perm_b32 v45, v18, v18, v35
v_perm_b32 v46, v18, v18, v37
v_perm_b32 v47, v18, v18, v39
v_mfma_f32_16x16x32_bf16 v[48:51], v[28:31], v[64:67], v[48:51]
v_perm_b32 v24, v19, v19, v32
v_perm_b32 v25, v19, v19, v34
v_perm_b32 v26, v19, v19, v36
v_perm_b32 v27, v19, v19, v38
v_mfma_f32_16x16x32_bf16 v[48:51], v[40:43], v[68:71], v[48:51]
v_perm_b32 v28, v19, v19, v33
v_perm_b32 v29, v19, v19, v35
v_perm_b32 v30, v19, v19, v37
v_perm_b32 v31, v19, v19, v39
v_mfma_f32_16x16x32_bf16 v[48:51], v[44:47], v[72:75], v[48:51]
v_perm_b32 v40, v20, v20, v32
v_perm_b32 v41, v20, v20, v34
v_perm_b32 v42, v20, v20, v36
v_perm_b32 v43, v20, v20, v38
v_mfma_f32_16x16x32_bf16 v[48:51], v[24:27], v[76:79], v[48:51]
v_perm_b32 v44, v20, v20, v33
v_perm_b32 v45, v20, v20, v35
v_perm_b32 v46, v20, v20, v37
v_perm_b32 v47, v20, v20, v39
v_mfma_f32_16x16x32_bf16 v[48:51], v[28:31], v[80:83], v[48:51]
v_perm_b32 v24, v21, v21, v32
v_perm_b32 v25, v21, v21, v34
v_perm_b32 v26, v21, v21, v36
v_perm_b32 v27, v21, v21, v38
v_mfma_f32_16x16x32_bf16 v[48:51], v[40:43], v[84:87], v[48:51]
v_perm_b32 v28, v21, v21, v33
v_perm_b32 v29, v21, v21, v35
v_perm_b32 v30, v21, v21, v37
v_perm_b32 v31, v21, v21, v39
v_mfma_f32_16x16x32_bf16 v[48:51], v[44:47], v[88:91], v[48:51]
v_perm_b32 v40, v22, v22, v32
v_perm_b32 v41, v22, v22, v34
v_perm_b32 v42, v22, v22, v36
v_perm_b32 v43, v22, v22, v38
v_mfma_f32_16x16x32_bf16 v[48:51], v[24:27], v[92:95], v[48:51]
v_perm_b32 v44, v22, v22, v33
v_perm_b32 v45, v22, v22, v35
v_perm_b32 v46, v22, v22, v37
v_perm_b32 v47, v22, v22, v39
s_waitcnt vmcnt(4)
v_mfma_f32_16x16x32_bf16 v[48:51], v[28:31], v[96:99], v[48:51]
v_perm_b32 v24, v23, v23, v32
v_perm_b32 v25, v23, v23, v34
v_perm_b32 v26, v23, v23, v36
v_perm_b32 v27, v23, v23, v38
s_waitcnt vmcnt(3)
v_mfma_f32_16x16x32_bf16 v[48:51], v[40:43], v[100:103], v[48:51]
v_perm_b32 v28, v23, v23, v33
v_perm_b32 v29, v23, v23, v35
v_perm_b32 v30, v23, v23, v37
v_perm_b32 v31, v23, v23, v39
s_waitcnt vmcnt(2)
v_mfma_f32_16x16x32_bf16 v[48:51], v[44:47], v[104:107], v[48:51]
s_waitcnt vmcnt(1)
v_mfma_f32_16x16x32_bf16 v[48:51], v[24:27], v[108:111], v[48:51]
s_waitcnt vmcnt(0)
v_mfma_f32_16x16x32_bf16 v[48:51], v[28:31], v[112:115], v[48:51]
s_nop 7
v_mov_b32 v24, v48
v_mov_b32 v25, v49
v_mov_b32 v26, v50
v_mov_b32 v27, v51
v_permlane32_swap_b32 v24, v48
v_permlane32_swap_b32 v25, v49
v_permlane32_swap_b32 v26, v50
v_permlane32_swap_b32 v27, v51
v_add_f32_dpp v24, v48, v24 row_ror:8 row_mask:0xf bank_mask:0xf
v_add_f32_dpp v25, v49, v25 row_ror:8 row_mask:0xf bank_mask:0xf
v_add_f32_dpp v26, v50, v26 row_ror:8 row_mask:0xf bank_mask:0xf
v_add_f32_dpp v27, v51, v27 row_ror:8 row_mask:0xf bank_mask:0xf
v_perm_b32 v24, v24, v11, s52
v_perm_b32 v25, v25, v11, s53
v_perm_b32 v26, v26, v11, s54
v_perm_b32 v27, v27, v11, s55
s_mov_b64 exec, 0x00ff00ff
buffer_store_dwordx4 v[24:27], v13, s[36:39], s58 offen sc1
s_mov_b64 exec, 1
ds_add_u32 v7, v15 offset:64
s_mov_b64 exec, -1
s_endpgm
L_ln:
s_setprio 3
s_add_u32 s62, s26, 2228224
s_addc_u32 s63, s27, 0
s_load_dword s31, s[26:27], 0
s_load_dword s57, s[62:63], 0
s_waitcnt vmcnt(0)
v_lshlrev_b32 v24, 16, v16
v_and_b32 v25, 0xffff0000, v16
v_lshlrev_b32 v26, 16, v17
v_and_b32 v27, 0xffff0000, v17
v_lshlrev_b32 v28, 16, v18
v_and_b32 v29, 0xffff0000, v18
v_lshlrev_b32 v30, 16, v19
v_and_b32 v31, 0xffff0000, v19
v_lshlrev_b32 v32, 16, v20
v_and_b32 v33, 0xffff0000, v20
v_lshlrev_b32 v34, 16, v21
v_and_b32 v35, 0xffff0000, v21
v_lshlrev_b32 v36, 16, v22
v_and_b32 v37, 0xffff0000, v22
v_lshlrev_b32 v38, 16, v23
v_and_b32 v39, 0xffff0000, v23
v_add_f32 v40, v24, v25
v_add_f32 v41, v26, v27
v_add_f32 v42, v28, v29
v_add_f32 v43, v30, v31
v_add_f32 v44, v32, v33
v_add_f32 v45, v34, v35
v_add_f32 v46, v36, v37
v_add_f32 v47, v38, v39
v_add_f32 v40, v40, v44
v_add_f32 v41, v41, v45
v_add_f32 v42, v42, v46
v_add_f32 v43, v43, v47
v_add_f32 v40, v40, v42
v_add_f32 v41, v41, v43
v_add_f32 v6, v40, v41
s_nop 1
v_add_f32_dpp v6, v6, v6 quad_perm:[1,0,3,2] row_mask:0xf bank_mask:0xf
s_nop 1
v_add_f32_dpp v6, v6, v6 quad_perm:[2,3,0,1] row_mask:0xf bank_mask:0xf
s_nop 1
v_add_f32_dpp v6, v6, v6 row_half_mirror row_mask:0xf bank_mask:0xf
s_nop 1
v_add_f32_dpp v6, v6, v6 row_mirror row_mask:0xf bank_mask:0xf
v_mov_b32 v13, v6
s_nop 1
v_permlane16_swap_b32 v13, v6
v_add_f32 v6, v6, v13
v_mov_b32 v13, v6
s_nop 1
v_permlane32_swap_b32 v13, v6
v_add_f32 v6, v6, v13
v_mul_f32 v6, 0x3a800000, v6
v_sub_f32 v40, v24, v6
v_sub_f32 v41, v25, v6
v_sub_f32 v42, v26, v6
v_sub_f32 v43, v27, v6
v_sub_f32 v44, v28, v6
v_sub_f32 v45, v29, v6
v_sub_f32 v46, v30, v6
v_sub_f32 v47, v31, v6
v_sub_f32 v48, v32, v6
v_sub_f32 v49, v33, v6
v_sub_f32 v50, v34, v6
v_sub_f32 v51, v35, v6
v_sub_f32 v52, v36, v6
v_sub_f32 v53, v37, v6
v_sub_f32 v54, v38, v6
v_sub_f32 v55, v39, v6
v_mul_f32 v10, v40, v40
v_mul_f32 v12, v41, v41
v_fmac_f32 v10, v42, v42
v_fmac_f32 v12, v43, v43
v_fmac_f32 v10, v44, v44
v_fmac_f32 v12, v45, v45
v_fmac_f32 v10, v46, v46
v_fmac_f32 v12, v47, v47
v_fmac_f32 v10, v48, v48
v_fmac_f32 v12, v49, v49
v_fmac_f32 v10, v50, v50
v_fmac_f32 v12, v51, v51
v_fmac_f32 v10, v52, v52
v_fmac_f32 v12, v53, v53
v_fmac_f32 v10, v54, v54
v_fmac_f32 v12, v55, v55
v_add_f32 v10, v10, v12
s_nop 1
v_add_f32_dpp v10, v10, v10 quad_perm:[1,0,3,2] row_mask:0xf bank_mask:0xf
s_nop 1
v_add_f32_dpp v10, v10, v10 quad_perm:[2,3,0,1] row_mask:0xf bank_mask:0xf
s_nop 1
v_add_f32_dpp v10, v10, v10 row_half_mirror row_mask:0xf bank_mask:0xf
s_nop 1
v_add_f32_dpp v10, v10, v10 row_mirror row_mask:0xf bank_mask:0xf
v_mov_b32 v13, v10
s_nop 1
v_permlane16_swap_b32 v13, v10
v_add_f32 v10, v10, v13
v_mov_b32 v13, v10
s_nop 1
v_permlane32_swap_b32 v13, v10
v_add_f32 v10, v10, v13
v_mul_f32 v10, 0x3a800000, v10
v_cvt_pk_bf16_f32 v6, v6, v6
v_lshlrev_b32 v6, 16, v6
v_cvt_pk_bf16_f32 v10, v10, v10
v_lshlrev_b32 v10, 16, v10
v_add_f32 v10, 0x3727c5ac, v10
v_cvt_pk_bf16_f32 v10, v10, v10
v_lshlrev_b32 v10, 16, v10
v_sqrt_f32 v10, v10
v_sub_f32 v24, v24, v6
v_sub_f32 v25, v25, v6
v_sub_f32 v26, v26, v6
v_sub_f32 v27, v27, v6
v_sub_f32 v28, v28, v6
v_sub_f32 v29, v29, v6
v_sub_f32 v30, v30, v6
v_sub_f32 v31, v31, v6
v_sub_f32 v32, v32, v6
v_sub_f32 v33, v33, v6
v_sub_f32 v34, v34, v6
v_sub_f32 v35, v35, v6
v_sub_f32 v36, v36, v6
v_sub_f32 v37, v37, v6
v_sub_f32 v38, v38, v6
v_sub_f32 v39, v39, v6
v_cvt_pk_bf16_f32 v10, v10, v10
v_lshlrev_b32 v10, 16, v10
v_rcp_f32 v10, v10
v_cvt_pk_bf16_f32 v16, v24, v25
v_cvt_pk_bf16_f32 v17, v26, v27
v_cvt_pk_bf16_f32 v18, v28, v29
v_cvt_pk_bf16_f32 v19, v30, v31
v_cvt_pk_bf16_f32 v20, v32, v33
v_cvt_pk_bf16_f32 v21, v34, v35
v_cvt_pk_bf16_f32 v22, v36, v37
v_cvt_pk_bf16_f32 v23, v38, v39
v_lshlrev_b32 v24, 16, v16
v_and_b32 v25, 0xffff0000, v16
v_mul_f32 v24, v24, v10
v_mul_f32 v25, v25, v10
v_cvt_pk_bf16_f32 v16, v24, v25
v_lshlrev_b32 v26, 16, v17
v_and_b32 v27, 0xffff0000, v17
v_mul_f32 v26, v26, v10
v_mul_f32 v27, v27, v10
v_cvt_pk_bf16_f32 v17, v26, v27
v_lshlrev_b32 v28, 16, v18
v_and_b32 v29, 0xffff0000, v18
v_mul_f32 v28, v28, v10
v_mul_f32 v29, v29, v10
v_cvt_pk_bf16_f32 v18, v28, v29
v_lshlrev_b32 v30, 16, v19
v_and_b32 v31, 0xffff0000, v19
v_mul_f32 v30, v30, v10
v_mul_f32 v31, v31, v10
v_cvt_pk_bf16_f32 v19, v30, v31
v_lshlrev_b32 v32, 16, v20
v_and_b32 v33, 0xffff0000, v20
v_mul_f32 v32, v32, v10
v_mul_f32 v33, v33, v10
v_cvt_pk_bf16_f32 v20, v32, v33
v_lshlrev_b32 v34, 16, v21
v_and_b32 v35, 0xffff0000, v21
v_mul_f32 v34, v34, v10
v_mul_f32 v35, v35, v10
v_cvt_pk_bf16_f32 v21, v34, v35
v_lshlrev_b32 v36, 16, v22
v_and_b32 v37, 0xffff0000, v22
v_mul_f32 v36, v36, v10
v_mul_f32 v37, v37, v10
v_cvt_pk_bf16_f32 v22, v36, v37
v_lshlrev_b32 v38, 16, v23
v_and_b32 v39, 0xffff0000, v23
v_mul_f32 v38, v38, v10
v_mul_f32 v39, v39, v10
v_cvt_pk_bf16_f32 v23, v38, v39
ds_write_b128 v5, v[16:19] offset:1024
ds_write_b128 v5, v[20:23] offset:1040
s_waitcnt lgkmcnt(0)
s_mul_i32 s31, s31, 0x9E3779B5
s_mul_i32 s57, s57, 0x85EBCA6C
s_add_u32 s31, s31, s57
s_add_u32 s31, s31, 0x6A09E667
v_mov_b32 v11, s31
ds_write_b32 v7, v11 offset:4
s_waitcnt lgkmcnt(0)
s_barrier
s_mov_b32 s36, s26
s_mov_b32 s37, s27
s_mov_b32 s38, 0x300000
s_mov_b32 s39, 0x20000
s_mov_b32 s52, 0x7060500
s_mov_b32 s53, 0x7060501
s_mov_b32 s54, 0x7060502
s_mov_b32 s55, 0x7060503
s_and_b32 s74, s31, 0xff
s_bfe_u32 s75, s31, 0x80008
s_bfe_u32 s76, s31, 0x80010
s_lshr_b32 s77, s31, 24
s_branch L_H3
L_other:
s_setprio 2
v_lshlrev_b32 v4, 2, v0
s_mov_b64 exec, 0x7ffffffc
ds_write_b32 v4, v7
s_mov_b64 exec, -1
s_waitcnt lgkmcnt(0)
s_mov_b32 s36, s26
s_mov_b32 s37, s27
s_mov_b32 s38, 0x300000
s_mov_b32 s39, 0x20000
s_mov_b32 s52, 0x7060500
s_mov_b32 s53, 0x7060501
s_mov_b32 s54, 0x7060502
s_mov_b32 s55, 0x7060503
v_and_b32 v12, 15, v0
v_lshlrev_b32 v12, 4, v12
v_lshrrev_b32 v10, 4, v0
v_lshl_add_u32 v14, v10, 9, v12
s_cmp_lt_u32 s3, 8
s_cbranch_scc1 L_gath
s_cmp_eq_u32 s3, 14
s_cbranch_scc1 L_Gred
s_cmp_eq_u32 s3, 15
s_cbranch_scc1 L_HG
s_lshr_b32 s47, s29, 2
s_and_b32 s45, s29, 3
s_lshr_b32 s46, s29, 4
s_lshl_b32 s46, s46, 2
s_add_u32 s46, s46, s45
s_and_b32 s49, s47, 3
s_cmp_eq_u32 s49, 3
s_cselect_b32 s45, s46, s45
s_cselect_b32 s47, 3, s47
s_cselect_b32 s41, -1, 0
s_cselect_b32 s40, 0xffff, 0
s_lshl_b32 s46, s28, 3
s_add_u32 s47, s47, s46
s_lshl_b32 s58, s47, 11
s_lshl_b32 s46, s45, 8
s_add_u32 s58, s58, s46
s_add_u32 s58, s58, 2097152
v_lshrrev_b32 v5, 5, v0
v_lshl_add_u32 v12, v5, 13, v12
v_and_b32 v1, 15, v0
v_lshlrev_b32 v1, 16, v1
v_lshl_add_u32 v1, v5, 9, v1
v_bfe_u32 v5, v0, 4, 1
v_lshl_add_u32 v1, v5, 12, v1
s_andn2_b32 s59, s28, 1
s_lshl_b32 s59, s59, 12
s_and_b32 s46, s47, 15
s_lshl_b32 s46, s46, 7
s_add_u32 s59, s59, s46
s_add_u32 s59, s59, s45
s_add_u32 s59, s59, 1081344
s_barrier
ds_read_b32 v11, v7 offset:4
s_waitcnt lgkmcnt(0)
v_readfirstlane_b32 s31, v11
s_nop 0
s_and_b32 s74, s31, 0xff
s_bfe_u32 s75, s31, 0x80008
s_bfe_u32 s76, s31, 0x80010
s_lshr_b32 s77, s31, 24
s_mov_b32 s60, 1600000
L_lw_3:
ds_read_b32 v13, v7 offset:8
ds_read_b128 v[24:27], v14 offset:3584
ds_read_b128 v[28:31], v14 offset:3840
s_waitcnt lgkmcnt(0)
v_readfirstlane_b32 s61, v13
s_nop 0
s_cmp_ge_u32 s61, 4
s_nop 1
s_cbranch_scc1 L_lwd_4
s_sub_u32 s60, s60, 1
s_cmp_lg_u32 s60, 0
s_cbranch_scc1 L_lw_3
L_lwd_4:
v_add_f32 v24, v24, v28
v_add_f32 v25, v25, v29
v_add_f32 v26, v26, v30
v_add_f32 v27, v27, v31
v_mov_b32 v28, v24
v_mov_b32 v29, v25
v_mov_b32 v30, v26
v_mov_b32 v31, v27
v_permlane16_swap_b32 v28, v24
v_permlane16_swap_b32 v29, v25
v_permlane16_swap_b32 v30, v26
v_permlane16_swap_b32 v31, v27
v_add_f32 v24, v24, v28
v_add_f32 v25, v25, v29
v_add_f32 v26, v26, v30
v_add_f32 v27, v27, v31
s_cmp_eq_u32 s49, 3
s_cbranch_scc1 L_qsp
v_mov_b32 v28, v24
v_mov_b32 v29, v25
v_mov_b32 v30, v26
v_mov_b32 v31, v27
v_permlane32_swap_b32 v28, v24
v_permlane32_swap_b32 v29, v25
v_permlane32_swap_b32 v30, v26
v_permlane32_swap_b32 v31, v27
v_add_f32 v24, v24, v28
v_add_f32 v25, v25, v29
v_add_f32 v26, v26, v30
v_add_f32 v27, v27, v31
L_qsp:
v_add_u32 v24, 0x80, v24
v_add_u32 v25, 0x80, v25
v_add_u32 v26, 0x80, v26
v_add_u32 v27, 0x80, v27
v_perm_b32 v24, v24, v11, s52
v_perm_b32 v25, v25, v11, s53
v_perm_b32 v26, v26, v11, s54
v_perm_b32 v27, v27, v11, s55
s_mov_b32 exec_lo, 0xffff
s_mov_b32 exec_hi, s40
buffer_store_dwordx4 v[24:27], v12, s[36:39], s58 offen sc1
s_endpgm
L_gath:
s_bitcmp1_b32 s29, 0
s_cbranch_scc0 L_H2
s_branch L_A2
L_HG:
s_bitcmp1_b32 s29, 0
s_cbranch_scc0 L_idle
s_lshr_b32 s45, s30, 2
s_mul_i32 s46, s45, 112
v_lshrrev_b32 v8, 1, v0
v_min_u32 v8, 27, v8
v_lshl_add_u32 v8, v8, 2, s46
v_lshrrev_b32 v9, 6, v8
v_and_b32 v8, 63, v8
v_lshlrev_b32 v8, 2, v8
v_lshl_add_u32 v8, v9, 11, v8
v_and_b32 v9, 1, v0
v_lshl_add_u32 v8, v9, 8, v8
s_mul_i32 s58, s28, 14336
s_add_u32 s58, s58, 610304
v_mul_u32_u24 v10, 37, v0
v_lshrrev_b32 v10, 8, v10
v_add_u32 v10, v10, v0
v_lshlrev_b32 v10, 2, v10
s_lshl_b32 s61, s45, 1
s_sub_u32 s61, s61, 1
s_max_i32 s61, s61, 0
s_min_u32 s61, s61, 4
s_lshl_b32 s61, s61, 7
s_add_u32 s61, s61, 2048
s_lshl_b32 s62, s2, 12
s_add_u32 s62, s62, 1048576
s_add_u32 s62, s62, s61
s_add_u32 s62, s26, s62
s_addc_u32 s63, s27, 0
s_barrier
ds_read_b32 v11, v7 offset:4
s_waitcnt lgkmcnt(0)
v_readfirstlane_b32 s31, v11
s_nop 0
s_and_b32 s74, s31, 0xff
s_bfe_u32 s75, s31, 0x80008
s_bfe_u32 s76, s31, 0x80010
s_lshr_b32 s77, s31, 24
s_mov_b32 s60, 1600000
L_lw_5:
ds_read_b32 v13, v7 offset:12
s_waitcnt lgkmcnt(0)
v_readfirstlane_b32 s61, v13
s_nop 0
s_cmp_ge_u32 s61, 4
s_nop 1
s_cbranch_scc1 L_lwd_6
s_sleep 2
s_sub_u32 s60, s60, 1
s_cmp_lg_u32 s60, 0
s_cbranch_scc1 L_lw_5
L_lwd_6:
s_and_b32 s56, s31, 0xff
s_mul_i32 s56, s56, 0x01010101
s_mov_b32 s60, 400000
L_hw_7:
s_load_dword s64, s[62:63], 0 glc
s_load_dword s65, s[62:63], 128 glc
s_load_dword s66, s[62:63], 256 glc
s_load_dword s67, s[62:63], 384 glc
s_waitcnt lgkmcnt(0)
s_xor_b32 s64, s64, s56
s_xor_b32 s65, s65, s56
s_or_b32 s64, s64, s65
s_xor_b32 s66, s66, s56
s_or_b32 s64, s64, s66
s_xor_b32 s67, s67, s56
s_or_b32 s64, s64, s67
s_cbranch_scc0 L_hwd_8
s_sleep 1
s_sub_u32 s60, s60, 1
s_cmp_lg_u32 s60, 0
s_cbranch_scc1 L_hw_7
L_hwd_8:
s_mov_b32 s60, 400000
L_gl_9:
buffer_load_dwordx4 v[24:27], v8, s[36:39], s58 offen offset:0 sc1
buffer_load_dwordx4 v[28:31], v8, s[36:39], s58 offen offset:1024 sc1
buffer_load_dwordx4 v[32:35], v8, s[36:39], s58 offen offset:512 sc1
buffer_load_dwordx4 v[36:39], v8, s[36:39], s58 offen offset:1536 sc1
L_glc_11:
s_waitcnt vmcnt(3)
v_xor_b32 v24, s74, v24
v_xor_b32 v25, s75, v25
v_xor_b32 v26, s76, v26
v_xor_b32 v27, s77, v27
v_or3_b32 v6, v24, v25, v26
v_or_b32 v6, v6, v27
s_waitcnt vmcnt(2)
v_xor_b32 v28, s74, v28
v_xor_b32 v29, s75, v29
v_xor_b32 v30, s76, v30
v_xor_b32 v31, s77, v31
v_or3_b32 v6, v6, v28, v29
v_or3_b32 v6, v6, v30, v31
s_waitcnt vmcnt(1)
v_xor_b32 v32, s74, v32
v_xor_b32 v33, s75, v33
v_xor_b32 v34, s76, v34
v_xor_b32 v35, s77, v35
v_or3_b32 v6, v6, v32, v33
v_or3_b32 v6, v6, v34, v35
s_waitcnt vmcnt(0)
v_xor_b32 v36, s74, v36
v_xor_b32 v37, s75, v37
v_xor_b32 v38, s76, v38
v_xor_b32 v39, s77, v39
v_or3_b32 v6, v6, v36, v37
v_or3_b32 v6, v6, v38, v39
v_and_b32 v6, 0xff, v6
v_cmp_ne_u32 vcc, 0, v6
s_nop 0
s_and_b64 exec, exec, vcc
s_cbranch_scc0 L_gld_10
s_sub_u32 s60, s60, 1
s_cmp_lg_u32 s60, 0
s_cbranch_scc1 L_gl_9
L_gld_10:
s_mov_b64 exec, -1
v_add_f32 v24, v24, v32
v_add_f32 v25, v25, v33
v_add_f32 v26, v26, v34
v_add_f32 v27, v27, v35
v_add_f32 v28, v28, v36
v_add_f32 v29, v29, v37
v_add_f32 v30, v30, v38
v_add_f32 v31, v31, v39
v_add_f32_dpp v24, v24, v24 quad_perm:[1,0,3,2] row_mask:0xf bank_mask:0xf
v_add_f32_dpp v25, v25, v25 quad_perm:[1,0,3,2] row_mask:0xf bank_mask:0xf
v_add_f32_dpp v26, v26, v26 quad_perm:[1,0,3,2] row_mask:0xf bank_mask:0xf
v_add_f32_dpp v27, v27, v27 quad_perm:[1,0,3,2] row_mask:0xf bank_mask:0xf
v_add_f32_dpp v28, v28, v28 quad_perm:[1,0,3,2] row_mask:0xf bank_mask:0xf
v_add_f32_dpp v29, v29, v29 quad_perm:[1,0,3,2] row_mask:0xf bank_mask:0xf
v_add_f32_dpp v30, v30, v30 quad_perm:[1,0,3,2] row_mask:0xf bank_mask:0xf
v_add_f32_dpp v31, v31, v31 quad_perm:[1,0,3,2] row_mask:0xf bank_mask:0xf
v_cmp_eq_u32 vcc, 1, v9
s_nop 1
v_cndmask_b32 v24, v24, v26, vcc
v_cndmask_b32 v25, v25, v27, vcc
v_cndmask_b32 v28, v28, v30, vcc
v_cndmask_b32 v29, v29, v31, vcc
v_cvt_pk_bf16_f32 v25, v24, v25
v_cvt_pk_bf16_f32 v29, v28, v29
v_lshlrev_b32 v24, 16, v25
v_and_b32 v25, 0xffff0000, v25
v_lshlrev_b32 v28, 16, v29
v_and_b32 v29, 0xffff0000, v29
v_mul_f32 v26, 0xbfb8aa3b, v24
v_mul_f32 v27, 0xbfb8aa3b, v25
v_exp_f32 v26, v26
v_exp_f32 v27, v27
v_add_f32 v26, 1.0, v26
v_add_f32 v27, 1.0, v27
v_rcp_f32 v26, v26
v_rcp_f32 v27, v27
v_mul_f32 v24, v24, v26
v_mul_f32 v25, v25, v27
v_cvt_pk_bf16_f32 v25, v24, v25
v_lshlrev_b32 v24, 16, v25
v_and_b32 v25, 0xffff0000, v25
v_mul_f32 v24, v24, v28
v_mul_f32 v25, v25, v29
v_cvt_pk_bf16_f32 v24, v24, v25
s_mov_b32 exec_hi, 0x00ffffff
ds_write_b32 v10, v24 offset:3076
s_mov_b64 exec, 1
ds_add_u32 v7, v15 offset:60
s_mov_b64 exec, -1
L_fin4:
s_endpgm
L_Gred:
s_cmp_ge_u32 s30, 14
s_cbranch_scc1 L_idle
s_lshr_b32 s45, s30, 1
s_add_u32 s46, s45, 1
s_cmp_eq_u32 s46, 7
s_cselect_b32 s46, 0, s46
s_lshl_b32 s47, s45, 11
s_lshl_b32 s46, s46, 11
s_add_u32 s46, s46, 1024
v_mov_b32 v13, s47
v_mov_b32 v5, s46
v_cmp_le_u32 vcc, 32, v0
s_nop 1
v_cndmask_b32 v13, v13, v5, vcc
v_add_u32 v13, v13, v12
s_and_b32 s46, s29, 1
s_lshl_b32 s46, s46, 1
s_and_b32 s47, s30, 1
s_add_u32 s46, s46, s47
s_mul_i32 s58, s28, 14336
s_lshl_b32 s47, s46, 8
s_add_u32 s58, s58, s47
s_add_u32 s58, s58, 610304
v_and_b32 v1, 15, v0
v_lshlrev_b32 v1, 16, v1
v_bfe_u32 v5, v0, 4, 1
v_mul_u32_u24 v5, 896, v5
v_sub_u32 v1, v1, v5
v_add_u32 v1, 896, v1
s_lshl_b32 s59, s28, 12
s_lshl_b32 s47, s45, 7
s_add_u32 s59, s59, s47
s_add_u32 s59, s59, s46
s_add_u32 s59, s59, 1082624
s_cmp_eq_u32 s45, 6
s_cselect_b32 s40, -1, 0xffff
s_barrier
ds_read_b32 v11, v7 offset:4
s_waitcnt lgkmcnt(0)
v_readfirstlane_b32 s31, v11
s_nop 0
s_and_b32 s74, s31, 0xff
s_bfe_u32 s75, s31, 0x80008
s_bfe_u32 s76, s31, 0x80010
s_lshr_b32 s77, s31, 24
s_mov_b32 s60, 1600000
L_lw_12:
ds_read_b32 v5, v7 offset:12
s_waitcnt lgkmcnt(0)
v_readfirstlane_b32 s61, v5
s_nop 0
s_cmp_ge_u32 s61, 1
s_nop 1
s_cbranch_scc1 L_lwd_13
s_sleep 2
s_sub_u32 s60, s60, 1
s_cmp_lg_u32 s60, 0
s_cbranch_scc1 L_lw_12
L_lwd_13:
s_mov_b32 s60, 1600000
L_lw_14:
ds_read_b32 v5, v7 offset:12
ds_read_b128 v[24:27], v14 offset:5632
ds_read_b128 v[28:31], v14 offset:5888
s_waitcnt lgkmcnt(0)
v_readfirstlane_b32 s61, v5
s_nop 0
s_cmp_ge_u32 s61, 4
s_nop 1
s_cbranch_scc1 L_lwd_15
s_sub_u32 s60, s60, 1
s_cmp_lg_u32 s60, 0
s_cbranch_scc1 L_lw_14
L_lwd_15:
v_add_f32 v24, v24, v28
v_add_f32 v25, v25, v29
v_add_f32 v26, v26, v30
v_add_f32 v27, v27, v31
v_mov_b32 v28, v24
v_mov_b32 v29, v25
v_mov_b32 v30, v26
v_mov_b32 v31, v27
v_permlane16_swap_b32 v28, v24
v_permlane16_swap_b32 v29, v25
v_permlane16_swap_b32 v30, v26
v_permlane16_swap_b32 v31, v27
v_add_f32 v24, v24, v28
v_add_f32 v25, v25, v29
v_add_f32 v26, v26, v30
v_add_f32 v27, v27, v31
v_add_u32 v24, 0x80, v24
v_add_u32 v25, 0x80, v25
v_add_u32 v26, 0x80, v26
v_add_u32 v27, 0x80, v27
v_perm_b32 v24, v24, v11, s52
v_perm_b32 v25, v25, v11, s53
v_perm_b32 v26, v26, v11, s54
v_perm_b32 v27, v27, v11, s55
s_mov_b32 exec_lo, 0xffff
s_mov_b32 exec_hi, 0xffff
buffer_store_dwordx4 v[24:27], v13, s[36:39], s58 offen sc1
s_mov_b32 exec_lo, s40
s_mov_b32 exec_hi, 0
buffer_store_byte v11, v1, s[36:39], s59 offen sc1
L_fin5:
s_endpgm
L_H2:
s_lshl_b32 s45, s28, 2
s_lshr_b32 s46, s30, 2
s_add_u32 s45, s45, s46
s_lshl_b32 s58, s45, 14
s_lshl_b32 s46, s44, 7
s_add_u32 s58, s58, s46
s_add_u32 s58, s58, 86016
s_add_u32 s40, s58, 4096
s_add_u32 s41, s58, 8192
s_add_u32 s42, s58, 12288
s_lshl_b32 s47, s45, 9
s_add_u32 s47, s47, 4096
v_lshlrev_b32 v8, 9, v2
v_lshl_add_u32 v8, v3, 4, v8
v_lshlrev_b32 v9, 4, v2
s_lshl_b32 s46, s44, 6
v_lshlrev_b32 v10, 1, v10
v_lshl_add_u32 v10, v3, 3, v10
v_add_u32 v10, s46, v10
s_lshl_b32 s61, s44, 8
s_lshl_b32 s62, s2, 12
s_add_u32 s62, s62, 1048576
s_add_u32 s62, s62, s61
s_add_u32 s62, s26, s62
s_addc_u32 s63, s27, 0
s_barrier
ds_read_b32 v11, v7 offset:4
s_waitcnt lgkmcnt(0)
v_readfirstlane_b32 s31, v11
s_nop 0
s_and_b32 s74, s31, 0xff
s_bfe_u32 s75, s31, 0x80008
s_bfe_u32 s76, s31, 0x80010
s_lshr_b32 s77, s31, 24
s_and_b32 s56, s31, 0xff
s_mul_i32 s56, s56, 0x01010101
s_mov_b32 s60, 400000
L_hw_16:
s_load_dword s64, s[62:63], 0 glc
s_load_dword s65, s[62:63], 128 glc
s_waitcnt lgkmcnt(0)
s_xor_b32 s64, s64, s56
s_xor_b32 s65, s65, s56
s_or_b32 s64, s64, s65
s_cbranch_scc0 L_hwd_17
s_sleep 1
s_sub_u32 s60, s60, 1
s_cmp_lg_u32 s60, 0
s_cbranch_scc1 L_hw_16
L_hwd_17:
s_mov_b64 exec, 1
ds_add_u32 v7, v15 offset:48
s_mov_b64 exec, -1
s_mov_b32 s60, 1600000
L_lw_18:
ds_read_b32 v12, v7 offset:48
s_waitcnt lgkmcnt(0)
v_readfirstlane_b32 s61, v12
s_nop 0
s_cmp_ge_u32 s61, 4
s_nop 1
s_cbranch_scc1 L_lwd_19
s_sleep 1
s_sub_u32 s60, s60, 1
s_cmp_lg_u32 s60, 0
s_cbranch_scc1 L_lw_18
L_lwd_19:
s_mov_b32 s60, 400000
L_gl_20:
buffer_load_dwordx4 v[24:27], v9, s[36:39], s47 offen offset:0 sc1
buffer_load_dwordx4 v[28:31], v9, s[36:39], s47 offen offset:128 sc1
buffer_load_dwordx4 v[32:35], v9, s[36:39], s47 offen offset:256 sc1
buffer_load_dwordx4 v[36:39], v9, s[36:39], s47 offen offset:384 sc1
buffer_load_dwordx4 v[40:43], v8, s[36:39], s58 offen sc1
buffer_load_dwordx4 v[44:47], v8, s[36:39], s40 offen sc1
buffer_load_dwordx4 v[48:51], v8, s[36:39], s41 offen sc1
buffer_load_dwordx4 v[52:55], v8, s[36:39], s42 offen sc1
L_glc_22:
s_waitcnt vmcnt(7)
v_xor_b32 v24, s74, v24
v_xor_b32 v25, s75, v25
v_xor_b32 v26, s76, v26
v_xor_b32 v27, s77, v27
v_or3_b32 v14, v24, v25, v26
v_or_b32 v14, v14, v27
s_waitcnt vmcnt(6)
v_xor_b32 v28, s74, v28
v_xor_b32 v29, s75, v29
v_xor_b32 v30, s76, v30
v_xor_b32 v31, s77, v31
v_or3_b32 v14, v14, v28, v29
v_or3_b32 v14, v14, v30, v31
s_waitcnt vmcnt(5)
v_xor_b32 v32, s74, v32
v_xor_b32 v33, s75, v33
v_xor_b32 v34, s76, v34
v_xor_b32 v35, s77, v35
v_or3_b32 v14, v14, v32, v33
v_or3_b32 v14, v14, v34, v35
s_waitcnt vmcnt(4)
v_xor_b32 v36, s74, v36
v_xor_b32 v37, s75, v37
v_xor_b32 v38, s76, v38
v_xor_b32 v39, s77, v39
v_or3_b32 v14, v14, v36, v37
v_or3_b32 v14, v14, v38, v39
s_waitcnt vmcnt(3)
v_xor_b32 v40, s74, v40
v_xor_b32 v41, s75, v41
v_xor_b32 v42, s76, v42
v_xor_b32 v43, s77, v43
v_or3_b32 v14, v14, v40, v41
v_or3_b32 v14, v14, v42, v43
s_waitcnt vmcnt(2)
v_xor_b32 v44, s74, v44
v_xor_b32 v45, s75, v45
v_xor_b32 v46, s76, v46
v_xor_b32 v47, s77, v47
v_or3_b32 v14, v14, v44, v45
v_or3_b32 v14, v14, v46, v47
s_waitcnt vmcnt(1)
v_xor_b32 v48, s74, v48
v_xor_b32 v49, s75, v49
v_xor_b32 v50, s76, v50
v_xor_b32 v51, s77, v51
v_or3_b32 v14, v14, v48, v49
v_or3_b32 v14, v14, v50, v51
s_waitcnt vmcnt(0)
v_xor_b32 v52, s74, v52
v_xor_b32 v53, s75, v53
v_xor_b32 v54, s76, v54
v_xor_b32 v55, s77, v55
v_or3_b32 v14, v14, v52, v53
v_or3_b32 v14, v14, v54, v55
v_and_b32 v14, 0xff, v14
v_cmp_ne_u32 vcc, 0, v14
s_nop 0
s_and_b64 exec, exec, vcc
s_cbranch_scc0 L_gld_21
s_sub_u32 s60, s60, 1
s_cmp_lg_u32 s60, 0
s_cbranch_scc1 L_gl_20
L_gld_21:
s_mov_b64 exec, -1
v_max3_f32 v12, v24, v28, v32
v_max_f32 v12, v12, v36
s_nop 1
v_max_f32_dpp v12, v12, v12 row_ror:8 row_mask:0xf bank_mask:0xf
v_mov_b32 v13, v12
s_nop 1
v_permlane16_swap_b32 v13, v12
v_max_f32 v12, v12, v13
v_mov_b32 v13, v12
s_nop 1
v_permlane32_swap_b32 v13, v12
v_max_f32 v12, v12, v13
s_mov_b32 s61, 0x3fb8aa3b
v_sub_f32 v24, v24, v12
v_sub_f32 v28, v28, v12
v_sub_f32 v32, v32, v12
v_sub_f32 v36, v36, v12
v_mul_f32 v24, s61, v24
v_mul_f32 v28, s61, v28
v_mul_f32 v32, s61, v32
v_mul_f32 v36, s61, v36
v_exp_f32 v24, v24
v_exp_f32 v28, v28
v_exp_f32 v32, v32
v_exp_f32 v36, v36
v_mul_f32 v56, v24, v25
v_mul_f32 v57, v24, v40
v_mul_f32 v58, v24, v41
v_mul_f32 v59, v24, v42
v_mul_f32 v60, v24, v43
v_fmac_f32 v56, v28, v29
v_fmac_f32 v57, v28, v44
v_fmac_f32 v58, v28, v45
v_fmac_f32 v59, v28, v46
v_fmac_f32 v60, v28, v47
v_fmac_f32 v56, v32, v33
v_fmac_f32 v57, v32, v48
v_fmac_f32 v58, v32, v49
v_fmac_f32 v59, v32, v50
v_fmac_f32 v60, v32, v51
v_fmac_f32 v56, v36, v37
v_fmac_f32 v57, v36, v52
v_fmac_f32 v58, v36, v53
v_fmac_f32 v59, v36, v54
v_fmac_f32 v60, v36, v55
v_add_f32_dpp v56, v56, v56 row_ror:8 row_mask:0xf bank_mask:0xf
v_add_f32_dpp v57, v57, v57 row_ror:8 row_mask:0xf bank_mask:0xf
v_add_f32_dpp v58, v58, v58 row_ror:8 row_mask:0xf bank_mask:0xf
v_add_f32_dpp v59, v59, v59 row_ror:8 row_mask:0xf bank_mask:0xf
v_add_f32_dpp v60, v60, v60 row_ror:8 row_mask:0xf bank_mask:0xf
v_mov_b32 v62, v56
v_permlane16_swap_b32 v57, v58
v_permlane16_swap_b32 v59, v60
v_permlane16_swap_b32 v62, v56
v_add_f32 v56, v56, v62
v_add_f32 v57, v57, v58
v_add_f32 v59, v59, v60
v_mov_b32 v62, v56
s_nop 0
v_permlane32_swap_b32 v57, v59
v_permlane32_swap_b32 v62, v56
v_add_f32 v56, v56, v62
v_rcp_f32 v56, v56
v_add_f32 v57, v57, v59
v_mul_f32 v57, v57, v56
v_cvt_pk_bf16_f32 v57, v57, v57
ds_write_b16 v10, v57 offset:3072
s_mov_b64 exec, 1
ds_add_u32 v7, v15 offset:56
s_mov_b64 exec, -1
s_endpgm
L_H3:
s_cmp_lt_u32 s29, 28
s_cbranch_scc1 L_noep
s_lshl_b32 s45, s28, 2
s_add_u32 s45, s45, s29
s_sub_u32 s45, s45, 28
s_mov_b32 s40, s4
s_mov_b32 s41, s5
s_mov_b32 s42, 0x800
s_mov_b32 s43, 0x20000
s_lshl_b32 s46, s45, 6
v_bfe_u32 v4, v0, 4, 1
v_lshlrev_b32 v4, 2, v4
v_lshl_add_u32 v4, v3, 3, v4
buffer_load_dword v8, v4, s[40:43], s46 offen
s_lshl_b32 s59, s45, 13
s_add_u32 s59, s59, 724992
s_add_u32 s58, s59, 4096
v_lshlrev_b32 v14, 4, v0
s_waitcnt vmcnt(0)
s_mov_b32 s40, s22
s_mov_b32 s41, s23
s_mov_b32 s42, 0x800
s_mov_b32 s43, 0x20000
v_lshlrev_b32 v16, 16, v8
v_and_b32 v17, 0xffff0000, v8
s_mov_b32 s60, 1600000
L_lw_23:
ds_read_b32 v5, v7 offset:64
s_waitcnt lgkmcnt(0)
v_readfirstlane_b32 s61, v5
s_nop 0
s_cmp_ge_u32 s61, 4
s_nop 1
s_cbranch_scc1 L_lwd_24
s_sleep 1
s_sub_u32 s60, s60, 1
s_cmp_lg_u32 s60, 0
s_cbranch_scc1 L_lw_23
L_lwd_24:
s_mov_b32 s60, 400000
L_gl_25:
buffer_load_dwordx4 v[24:27], v14, s[36:39], s59 offen offset:0 sc1
buffer_load_dwordx4 v[28:31], v14, s[36:39], s59 offen offset:1024 sc1
buffer_load_dwordx4 v[32:35], v14, s[36:39], s59 offen offset:2048 sc1
buffer_load_dwordx4 v[36:39], v14, s[36:39], s59 offen offset:3072 sc1
buffer_load_dwordx4 v[40:43], v14, s[36:39], s58 offen offset:0 sc1
buffer_load_dwordx4 v[44:47], v14, s[36:39], s58 offen offset:1024 sc1
buffer_load_dwordx4 v[48:51], v14, s[36:39], s58 offen offset:2048 sc1
buffer_load_dwordx4 v[52:55], v14, s[36:39], s58 offen offset:3072 sc1
L_glc_27:
s_waitcnt vmcnt(7)
v_xor_b32 v24, s74, v24
v_xor_b32 v25, s75, v25
v_xor_b32 v26, s76, v26
v_xor_b32 v27, s77, v27
v_or3_b32 v10, v24, v25, v26
v_or_b32 v10, v10, v27
s_waitcnt vmcnt(6)
v_xor_b32 v28, s74, v28
v_xor_b32 v29, s75, v29
v_xor_b32 v30, s76, v30
v_xor_b32 v31, s77, v31
v_or3_b32 v10, v10, v28, v29
v_or3_b32 v10, v10, v30, v31
s_waitcnt vmcnt(5)
v_xor_b32 v32, s74, v32
v_xor_b32 v33, s75, v33
v_xor_b32 v34, s76, v34
v_xor_b32 v35, s77, v35
v_or3_b32 v10, v10, v32, v33
v_or3_b32 v10, v10, v34, v35
s_waitcnt vmcnt(4)
v_xor_b32 v36, s74, v36
v_xor_b32 v37, s75, v37
v_xor_b32 v38, s76, v38
v_xor_b32 v39, s77, v39
v_or3_b32 v10, v10, v36, v37
v_or3_b32 v10, v10, v38, v39
s_waitcnt vmcnt(3)
v_xor_b32 v40, s74, v40
v_xor_b32 v41, s75, v41
v_xor_b32 v42, s76, v42
v_xor_b32 v43, s77, v43
v_or3_b32 v10, v10, v40, v41
v_or3_b32 v10, v10, v42, v43
s_waitcnt vmcnt(2)
v_xor_b32 v44, s74, v44
v_xor_b32 v45, s75, v45
v_xor_b32 v46, s76, v46
v_xor_b32 v47, s77, v47
v_or3_b32 v10, v10, v44, v45
v_or3_b32 v10, v10, v46, v47
s_waitcnt vmcnt(1)
v_xor_b32 v48, s74, v48
v_xor_b32 v49, s75, v49
v_xor_b32 v50, s76, v50
v_xor_b32 v51, s77, v51
v_or3_b32 v10, v10, v48, v49
v_or3_b32 v10, v10, v50, v51
s_waitcnt vmcnt(0)
v_xor_b32 v52, s74, v52
v_xor_b32 v53, s75, v53
v_xor_b32 v54, s76, v54
v_xor_b32 v55, s77, v55
v_or3_b32 v10, v10, v52, v53
v_or3_b32 v10, v10, v54, v55
v_and_b32 v10, 0xff, v10
v_cmp_ne_u32 vcc, 0, v10
s_nop 0
s_and_b64 exec, exec, vcc
s_cbranch_scc0 L_gld_26
s_sub_u32 s60, s60, 1
s_cmp_lg_u32 s60, 0
s_cbranch_scc1 L_gl_25
L_gld_26:
s_mov_b64 exec, -1
v_add_f32 v24, v24, v28
v_add_f32 v32, v32, v36
v_add_f32 v25, v25, v29
v_add_f32 v33, v33, v37
v_add_f32 v26, v26, v30
v_add_f32 v34, v34, v38
v_add_f32 v27, v27, v31
v_add_f32 v35, v35, v39
v_add_f32 v40, v40, v44
v_add_f32 v48, v48, v52
v_add_f32 v41, v41, v45
v_add_f32 v49, v49, v53
v_add_f32 v42, v42, v46
v_add_f32 v50, v50, v54
v_add_f32 v43, v43, v47
v_add_f32 v51, v51, v55
v_add_f32 v24, v24, v32
v_add_f32 v28, v40, v48
v_add_f32 v25, v25, v33
v_add_f32 v29, v41, v49
v_add_f32 v26, v26, v34
v_add_f32 v30, v42, v50
v_add_f32 v27, v27, v35
v_add_f32 v31, v43, v51
v_permlane32_swap_b32 v24, v28
v_permlane32_swap_b32 v25, v29
v_permlane32_swap_b32 v26, v30
v_permlane32_swap_b32 v27, v31
v_add_f32 v28, v24, v28
v_add_f32 v29, v25, v29
v_add_f32 v30, v26, v30
v_add_f32 v31, v27, v31
s_nop 0
v_permlane16_swap_b32 v28, v30
v_permlane16_swap_b32 v29, v31
v_add_f32 v28, v28, v30
v_add_f32 v29, v29, v31
s_nop 0
v_add_f32_dpp v28, v28, v28 row_ror:8 row_mask:0xf bank_mask:0xf
v_add_f32_dpp v29, v29, v29 row_ror:8 row_mask:0xf bank_mask:0xf
v_cvt_pk_bf16_f32 v28, v28, v29
v_mov_b32 v30, v28
s_nop 1
v_permlane32_swap_b32 v28, v30
v_lshlrev_b32 v32, 16, v28
v_and_b32 v33, 0xffff0000, v28
v_add_f32 v32, v32, v16
v_add_f32 v33, v33, v17
v_lshlrev_b32 v36, 16, v30
v_cvt_pk_bf16_f32 v28, v32, v33
v_and_b32 v37, 0xffff0000, v30
v_lshlrev_b32 v32, 16, v28
v_and_b32 v33, 0xffff0000, v28
v_add_f32 v32, v32, v36
v_add_f32 v33, v33, v37
v_cvt_pk_bf16_f32 v28, v32, v33
s_mov_b64 exec, 0x00ff00ff
buffer_store_dword v28, v4, s[40:43], s46 offen
s_mov_b64 exec, 1
s_cmp_lg_u32 s45, 0
s_cbranch_scc1 L_noep
s_mov_b32 s46, 2228224
buffer_store_dword v11, v7, s[36:39], 0 offen offset:0
buffer_store_dword v11, v7, s[36:39], s46 offen
L_noep:
s_endpgm
L_idle:
s_barrier
s_endpgm
L_A2:
s_lshr_b32 s45, s28, 1
s_and_b32 s46, s28, 1
s_lshl_b32 s46, s46, 4
s_add_u32 s46, s46, s30
s_lshl_b32 s49, s44, 13
s_add_u32 s49, s49, 12288
v_lshrrev_b32 v4, 4, v0
v_and_b32 v5, 15, v0
v_xor_b32 v6, v5, v4
v_lshlrev_b32 v6, 4, v6
v_lshl_add_u32 v8, v5, 8, v6
v_add_u32 v8, s49, v8
v_xor_b32 v9, 64, v8
v_xor_b32 v10, 128, v8
v_xor_b32 v14, 192, v8
s_lshl_b32 s48, s44, 2
v_mov_b32 v22, s48
v_lshrrev_b32 v16, 5, v0
s_lshl_b32 s48, s44, 1
v_add_u32 v16, s48, v16
v_and_b32 v17, 31, v0
v_mul_u32_u24 v18, 528, v16
v_lshl_add_u32 v18, v17, 4, v18
v_lshlrev_b32 v19, 4, v16
v_lshlrev_b32 v20, 14, v16
v_lshl_add_u32 v20, v17, 4, v20
v_lshlrev_b32 v21, 9, v16
s_lshl_b32 s48, s45, 8
s_add_u32 s48, s48, s46
s_lshl_b32 s58, s48, 9
s_add_u32 s58, s58, 86016
s_lshl_b32 s59, s48, 4
s_add_u32 s59, s59, 4096
v_lshlrev_b32 v1, 16, v5
v_bfe_u32 v13, v0, 4, 1
v_lshl_add_u32 v1, v13, 12, v1
s_lshl_b32 s47, s45, 13
s_lshr_b32 s48, s46, 2
s_lshl_b32 s48, s48, 7
s_add_u32 s47, s47, s48
s_and_b32 s48, s46, 3
s_add_u32 s47, s47, s48
s_add_u32 s47, s47, 1048576
s_lshl_b32 s40, s45, 15
s_lshl_b32 s48, s44, 13
s_add_u32 s40, s40, s48
s_add_u32 s40, s40, 2097152
v_lshl_add_u32 v16, v4, 11, v12
v_lshl_add_u32 v120, v4, 8, v12
v_add_u32 v120, 7168, v120
v_cmp_eq_u32 vcc, 3, v4
s_nop 1
v_cndmask_b32 v121, 0, 1.0, vcc
v_lshrrev_b32 v17, 1, v4
v_mul_u32_u24 v17, 272, v17
v_lshl_add_u32 v17, v13, 7, v17
v_lshl_add_u32 v17, v5, 3, v17
s_mul_i32 s61, s44, 544
v_add_u32 v17, s61, v17
s_lshl_b32 s61, s44, 9
s_lshl_b32 s62, s2, 12
s_add_u32 s62, s62, 1048576
s_add_u32 s62, s62, s61
s_add_u32 s62, s26, s62
s_addc_u32 s63, s27, 0
v_lshrrev_b32 v12, 2, v0
v_and_b32 v13, 7, v12
v_lshlrev_b32 v13, 1, v13
v_bfe_u32 v23, v0, 1, 1
v_xor_b32 v13, v13, v23
v_lshlrev_b32 v13, 4, v13
v_lshl_add_u32 v13, v12, 8, v13
v_and_b32 v23, 1, v0
v_lshl_add_u32 v13, v23, 3, v13
s_add_u32 s48, s49, 32768
v_add_u32 v13, s48, v13
s_mov_b32 s48, 0x3db504f3
s_mov_b32 s43, 0x3fb8aa3b
s_barrier
ds_read_b32 v11, v7 offset:4
s_waitcnt lgkmcnt(0)
v_readfirstlane_b32 s31, v11
s_nop 0
s_and_b32 s74, s31, 0xff
s_bfe_u32 s75, s31, 0x80008
s_bfe_u32 s76, s31, 0x80010
s_lshr_b32 s77, s31, 24
s_mov_b32 s60, 1600000
L_lw_28:
ds_read_b32 v12, v7 offset:68
s_waitcnt lgkmcnt(0)
v_readfirstlane_b32 s61, v12
s_nop 0
s_cmp_ge_u32 s61, 4
s_nop 1
s_cbranch_scc1 L_lwd_29
s_sleep 1
s_sub_u32 s60, s60, 1
s_cmp_lg_u32 s60, 0
s_cbranch_scc1 L_lw_28
L_lwd_29:
s_setprio 3
buffer_load_dwordx4 v[104:107], v120, s[36:39], s40 offen sc1
buffer_load_dwordx4 v[24:27], v16, s[36:39], s40 offen offset:0 sc1
buffer_load_dwordx4 v[28:31], v16, s[36:39], s40 offen offset:256 sc1
buffer_load_dwordx4 v[32:35], v16, s[36:39], s40 offen offset:512 sc1
buffer_load_dwordx4 v[36:39], v16, s[36:39], s40 offen offset:768 sc1
s_mov_b32 s60, 1600000
L_lw_30:
ds_read_b32 v12, v22 offset:16
s_waitcnt lgkmcnt(0)
v_readfirstlane_b32 s61, v12
s_nop 0
s_cmp_ge_u32 s61, 1
s_nop 1
s_cbranch_scc1 L_lwd_31
s_sub_u32 s60, s60, 1
s_cmp_lg_u32 s60, 0
s_cbranch_scc1 L_lw_30
L_lwd_31:
ds_read_b128 v[40:43], v8 offset:0
ds_read_b128 v[44:47], v9 offset:0
ds_read_b128 v[48:51], v10 offset:0
ds_read_b128 v[52:55], v14 offset:0
ds_read_b128 v[56:59], v8 offset:4096
ds_read_b128 v[60:63], v9 offset:4096
ds_read_b128 v[64:67], v10 offset:4096
ds_read_b128 v[68:71], v14 offset:4096
v_mul_u32_u24 v10, 272, v3
v_lshl_add_u32 v10, v4, 4, v10
v_mul_u32_u24 v8, 528, v3
v_lshl_add_u32 v8, v4, 4, v8
v_add_u32 v8, s49, v8
v_lshl_add_u32 v9, v3, 4, v22
s_mov_b32 s60, 400000
s_branch L_glc_34
L_gl_32:
buffer_load_dwordx4 v[104:107], v120, s[36:39], s40 offen sc1
buffer_load_dwordx4 v[24:27], v16, s[36:39], s40 offen offset:0 sc1
buffer_load_dwordx4 v[28:31], v16, s[36:39], s40 offen offset:256 sc1
buffer_load_dwordx4 v[32:35], v16, s[36:39], s40 offen offset:512 sc1
buffer_load_dwordx4 v[36:39], v16, s[36:39], s40 offen offset:768 sc1
L_glc_34:
s_waitcnt vmcnt(4)
v_xor_b32 v104, s74, v104
v_xor_b32 v105, s75, v105
v_xor_b32 v106, s76, v106
v_xor_b32 v107, s77, v107
v_or3_b32 v6, v104, v105, v106
v_or_b32 v6, v6, v107
s_waitcnt vmcnt(3)
v_xor_b32 v24, s74, v24
v_xor_b32 v25, s75, v25
v_xor_b32 v26, s76, v26
v_xor_b32 v27, s77, v27
v_or3_b32 v6, v6, v24, v25
v_or3_b32 v6, v6, v26, v27
s_waitcnt vmcnt(2)
v_xor_b32 v28, s74, v28
v_xor_b32 v29, s75, v29
v_xor_b32 v30, s76, v30
v_xor_b32 v31, s77, v31
v_or3_b32 v6, v6, v28, v29
v_or3_b32 v6, v6, v30, v31
s_waitcnt vmcnt(1)
v_xor_b32 v32, s74, v32
v_xor_b32 v33, s75, v33
v_xor_b32 v34, s76, v34
v_xor_b32 v35, s77, v35
v_or3_b32 v6, v6, v32, v33
v_or3_b32 v6, v6, v34, v35
s_waitcnt vmcnt(0)
v_xor_b32 v36, s74, v36
v_xor_b32 v37, s75, v37
v_xor_b32 v38, s76, v38
v_xor_b32 v39, s77, v39
v_or3_b32 v6, v6, v36, v37
v_or3_b32 v6, v6, v38, v39
v_and_b32 v6, 0xff, v6
v_cmp_ne_u32 vcc, 0, v6
s_nop 0
s_and_b64 exec, exec, vcc
s_cbranch_scc0 L_gld_33
s_sub_u32 s60, s60, 1
s_cmp_lg_u32 s60, 0
s_cbranch_scc1 L_gl_32
L_gld_33:
s_mov_b64 exec, -1
v_mov_b32 v108, v104
v_mov_b32 v109, v105
v_mov_b32 v110, v106
v_mov_b32 v111, v107
v_add_f32 v24, v24, v28
v_add_f32 v25, v25, v29
v_add_f32 v26, v26, v30
v_add_f32 v27, v27, v31
v_permlane16_swap_b32 v108, v104
v_permlane16_swap_b32 v109, v105
v_permlane16_swap_b32 v110, v106
v_permlane16_swap_b32 v111, v107
v_add_f32 v104, v104, v108
v_add_f32 v105, v105, v109
v_add_f32 v106, v106, v110
v_add_f32 v107, v107, v111
v_mov_b32 v108, v104
v_mov_b32 v109, v105
v_mov_b32 v110, v106
v_mov_b32 v111, v107
v_add_f32 v32, v32, v36
v_add_f32 v33, v33, v37
v_add_f32 v34, v34, v38
v_add_f32 v35, v35, v39
v_permlane32_swap_b32 v108, v104
v_permlane32_swap_b32 v109, v105
v_permlane32_swap_b32 v110, v106
v_permlane32_swap_b32 v111, v107
v_add_f32 v104, v104, v108
v_add_f32 v105, v105, v109
v_add_f32 v106, v106, v110
v_add_f32 v107, v107, v111
v_add_f32 v24, v24, v32
v_add_f32 v25, v25, v33
v_add_f32 v26, v26, v34
v_add_f32 v27, v27, v35
v_fmac_f32 v24, v121, v104
v_fmac_f32 v25, v121, v105
v_fmac_f32 v26, v121, v106
v_fmac_f32 v27, v121, v107
v_cvt_pk_bf16_f32 v24, v24, v25
v_cvt_pk_bf16_f32 v25, v26, v27
ds_write_b64 v17, v[24:25] offset:7680
s_mov_b64 exec, 1
ds_add_u32 v7, v15 offset:48
s_mov_b64 exec, -1
s_mov_b32 s60, 1600000
L_lw_35:
ds_read_b32 v12, v22 offset:32
s_waitcnt lgkmcnt(0)
v_readfirstlane_b32 s61, v12
s_nop 0
s_cmp_ge_u32 s61, 1
s_nop 1
s_cbranch_scc1 L_lwd_36
s_sub_u32 s60, s60, 1
s_cmp_lg_u32 s60, 0
s_cbranch_scc1 L_lw_35
L_lwd_36:
ds_read_b64_tr_b16 v[72:73], v13
ds_read_b64_tr_b16 v[74:75], v13 offset:4096
v_xor_b32 v12, 32, v13
ds_read_b64_tr_b16 v[76:77], v12
ds_read_b64_tr_b16 v[78:79], v12 offset:4096
v_xor_b32 v12, 64, v13
ds_read_b64_tr_b16 v[80:81], v12
ds_read_b64_tr_b16 v[82:83], v12 offset:4096
v_xor_b32 v12, 96, v13
ds_read_b64_tr_b16 v[84:85], v12
ds_read_b64_tr_b16 v[86:87], v12 offset:4096
v_xor_b32 v12, 128, v13
ds_read_b64_tr_b16 v[88:89], v12
ds_read_b64_tr_b16 v[90:91], v12 offset:4096
v_xor_b32 v12, 160, v13
ds_read_b64_tr_b16 v[92:93], v12
ds_read_b64_tr_b16 v[94:95], v12 offset:4096
v_xor_b32 v12, 192, v13
ds_read_b64_tr_b16 v[96:97], v12
ds_read_b64_tr_b16 v[98:99], v12 offset:4096
v_xor_b32 v12, 224, v13
ds_read_b64_tr_b16 v[100:101], v12
ds_read_b64_tr_b16 v[102:103], v12 offset:4096
s_mov_b32 s60, 1600000
L_lw_37:
ds_read_b32 v12, v7 offset:48
ds_read_b128 v[104:107], v10 offset:7680
ds_read_b128 v[108:111], v10 offset:7744
ds_read_b128 v[112:115], v10 offset:7808
ds_read_b128 v[116:119], v10 offset:7872
s_waitcnt lgkmcnt(0)
v_readfirstlane_b32 s61, v12
s_nop 0
s_cmp_ge_u32 s61, 4
s_nop 1
s_cbranch_scc1 L_lwd_38
s_sub_u32 s60, s60, 1
s_cmp_lg_u32 s60, 0
s_cbranch_scc1 L_lw_37
L_lwd_38:
v_mfma_f32_16x16x32_bf16 v[24:27], v[40:43], v[104:107], 0
v_mfma_f32_16x16x32_bf16 v[28:31], v[56:59], v[104:107], 0
v_mfma_f32_16x16x32_bf16 v[24:27], v[44:47], v[108:111], v[24:27]
v_mfma_f32_16x16x32_bf16 v[28:31], v[60:63], v[108:111], v[28:31]
v_mfma_f32_16x16x32_bf16 v[24:27], v[48:51], v[112:115], v[24:27]
v_mfma_f32_16x16x32_bf16 v[28:31], v[64:67], v[112:115], v[28:31]
v_mfma_f32_16x16x32_bf16 v[24:27], v[52:55], v[116:119], v[24:27]
v_mfma_f32_16x16x32_bf16 v[28:31], v[68:71], v[116:119], v[28:31]
s_nop 6
v_cvt_pk_bf16_f32 v25, v24, v25
v_cvt_pk_bf16_f32 v27, v26, v27
v_cvt_pk_bf16_f32 v29, v28, v29
v_cvt_pk_bf16_f32 v31, v30, v31
v_lshlrev_b32 v24, 16, v25
v_and_b32 v25, 0xffff0000, v25
v_lshlrev_b32 v26, 16, v27
v_and_b32 v27, 0xffff0000, v27
v_lshlrev_b32 v28, 16, v29
v_and_b32 v29, 0xffff0000, v29
v_lshlrev_b32 v30, 16, v31
v_and_b32 v31, 0xffff0000, v31
v_mul_f32 v24, s48, v24
v_mul_f32 v25, s48, v25
v_mul_f32 v26, s48, v26
v_mul_f32 v27, s48, v27
v_mul_f32 v28, s48, v28
v_mul_f32 v29, s48, v29
v_mul_f32 v30, s48, v30
v_mul_f32 v31, s48, v31
v_cvt_pk_bf16_f32 v25, v24, v25
v_cvt_pk_bf16_f32 v27, v26, v27
v_cvt_pk_bf16_f32 v29, v28, v29
v_cvt_pk_bf16_f32 v31, v30, v31
v_lshlrev_b32 v24, 16, v25
v_and_b32 v25, 0xffff0000, v25
v_lshlrev_b32 v26, 16, v27
v_and_b32 v27, 0xffff0000, v27
v_lshlrev_b32 v28, 16, v29
v_and_b32 v29, 0xffff0000, v29
v_lshlrev_b32 v30, 16, v31
v_and_b32 v31, 0xffff0000, v31
v_max3_f32 v32, v24, v25, v26
v_max3_f32 v33, v27, v28, v29
v_max3_f32 v32, v32, v30, v31
v_max_f32 v32, v32, v33
v_mov_b32 v33, v32
s_nop 1
v_permlane16_swap_b32 v33, v32
v_max_f32 v32, v32, v33
v_mov_b32 v33, v32
s_nop 1
v_permlane32_swap_b32 v33, v32
v_max_f32 v32, v32, v33
v_sub_f32 v24, v24, v32
v_sub_f32 v25, v25, v32
v_sub_f32 v26, v26, v32
v_sub_f32 v27, v27, v32
v_sub_f32 v28, v28, v32
v_sub_f32 v29, v29, v32
v_sub_f32 v30, v30, v32
v_sub_f32 v31, v31, v32
v_mul_f32 v24, s43, v24
v_mul_f32 v25, s43, v25
v_mul_f32 v26, s43, v26
v_mul_f32 v27, s43, v27
v_mul_f32 v28, s43, v28
v_mul_f32 v29, s43, v29
v_mul_f32 v30, s43, v30
v_mul_f32 v31, s43, v31
v_exp_f32 v24, v24
v_exp_f32 v25, v25
v_exp_f32 v26, v26
v_exp_f32 v27, v27
v_exp_f32 v28, v28
v_exp_f32 v29, v29
v_exp_f32 v30, v30
v_exp_f32 v31, v31
v_cvt_pk_bf16_f32 v36, v24, v25
v_cvt_pk_bf16_f32 v37, v26, v27
v_cvt_pk_bf16_f32 v38, v28, v29
v_cvt_pk_bf16_f32 v39, v30, v31
s_nop 1
v_mfma_f32_16x16x32_bf16 v[40:43], v[72:75], v[36:39], 0
v_add_f32 v24, v24, v28
v_mfma_f32_16x16x32_bf16 v[44:47], v[76:79], v[36:39], 0
v_add_f32 v25, v25, v29
v_mfma_f32_16x16x32_bf16 v[48:51], v[80:83], v[36:39], 0
v_add_f32 v26, v26, v30
v_mfma_f32_16x16x32_bf16 v[52:55], v[84:87], v[36:39], 0
v_add_f32 v27, v27, v31
v_mfma_f32_16x16x32_bf16 v[56:59], v[88:91], v[36:39], 0
v_add_f32 v24, v24, v26
v_mfma_f32_16x16x32_bf16 v[60:63], v[92:95], v[36:39], 0
v_add_f32 v25, v25, v27
v_mfma_f32_16x16x32_bf16 v[64:67], v[96:99], v[36:39], 0
v_add_f32 v24, v24, v25
v_mfma_f32_16x16x32_bf16 v[68:71], v[100:103], v[36:39], 0
v_mov_b32 v25, v24
s_mov_b32 exec_lo, 0x00ff00ff
s_mov_b32 exec_hi, 0x00ff00ff
ds_write_b128 v8, v[40:43] offset:0
ds_write_b128 v8, v[44:47] offset:64
ds_write_b128 v8, v[48:51] offset:128
ds_write_b128 v8, v[52:55] offset:192
ds_write_b128 v8, v[56:59] offset:256
ds_write_b128 v8, v[60:63] offset:320
ds_write_b128 v8, v[64:67] offset:384
ds_write_b128 v8, v[68:71] offset:448
s_mov_b64 exec, -1
v_permlane16_swap_b32 v25, v24
v_add_f32 v24, v24, v25
v_mov_b32 v25, v24
s_nop 1
v_permlane32_swap_b32 v25, v24
v_add_f32 v24, v24, v25
s_mov_b64 exec, 0xff
ds_write_b32 v9, v32 offset:256
ds_write_b32 v9, v24 offset:384
s_mov_b64 exec, 1
ds_add_u32 v7, v15 offset:52
s_mov_b64 exec, -1
s_mov_b32 s60, 1600000
L_lw_39:
ds_read_b32 v12, v7 offset:52
ds_read_b128 v[24:27], v19 offset:256
ds_read_b128 v[28:31], v19 offset:384
ds_read_b128 v[40:43], v18 offset:12288
ds_read_b128 v[44:47], v18 offset:20480
ds_read_b128 v[48:51], v18 offset:28672
ds_read_b128 v[52:55], v18 offset:36864
s_waitcnt lgkmcnt(0)
v_readfirstlane_b32 s61, v12
s_nop 0
s_cmp_ge_u32 s61, 4
s_nop 1
s_cbranch_scc1 L_lwd_40
s_sub_u32 s60, s60, 1
s_cmp_lg_u32 s60, 0
s_cbranch_scc1 L_lw_39
L_lwd_40:
v_max3_f32 v32, v24, v25, v26
v_max_f32 v32, v32, v27
v_sub_f32 v24, v24, v32
v_sub_f32 v25, v25, v32
v_sub_f32 v26, v26, v32
v_sub_f32 v27, v27, v32
v_mul_f32 v24, s43, v24
v_mul_f32 v25, s43, v25
v_mul_f32 v26, s43, v26
v_mul_f32 v27, s43, v27
v_exp_f32 v24, v24
v_exp_f32 v25, v25
v_exp_f32 v26, v26
v_exp_f32 v27, v27
v_mul_f32 v36, v24, v40
v_mul_f32 v37, v24, v41
v_mul_f32 v38, v24, v42
v_mul_f32 v39, v24, v43
v_fmac_f32 v36, v25, v44
v_fmac_f32 v37, v25, v45
v_fmac_f32 v38, v25, v46
v_fmac_f32 v39, v25, v47
v_fmac_f32 v36, v26, v48
v_fmac_f32 v37, v26, v49
v_fmac_f32 v38, v26, v50
v_fmac_f32 v39, v26, v51
v_fmac_f32 v36, v27, v52
v_fmac_f32 v37, v27, v53
v_fmac_f32 v38, v27, v54
v_fmac_f32 v39, v27, v55
v_perm_b32 v36, v36, v11, s52
v_perm_b32 v37, v37, v11, s53
v_perm_b32 v38, v38, v11, s54
v_perm_b32 v39, v39, v11, s55
buffer_store_dwordx4 v[36:39], v20, s[36:39], s58 offen sc1
v_mul_f32 v33, v24, v28
v_fmac_f32 v33, v25, v29
v_fmac_f32 v33, v26, v30
v_fmac_f32 v33, v27, v31
v_perm_b32 v32, v32, v11, s52
v_perm_b32 v33, v33, v11, s53
v_perm_b32 v34, v34, v11, s54
v_perm_b32 v35, v35, v11, s55
s_mov_b32 exec_lo, 1
s_mov_b32 exec_hi, 1
buffer_store_dwordx4 v[32:35], v21, s[36:39], s59 offen sc1
s_cmp_lg_u32 s44, 3
s_cbranch_scc1 L_A_nohint
s_mov_b32 exec_lo, -1
s_mov_b32 exec_hi, 0
buffer_store_byte v11, v1, s[36:39], s47 offen sc1
L_A_nohint:
L_end:
s_endpgm
L_code_end:
.section .rodata,"a"
.p2align 6
.amdhsa_kernel parallel_sum__sliding_block_cached__swiglu_ffn__decode_kernel
  .amdhsa_next_free_vgpr 124
  .amdhsa_next_free_sgpr 96
  .amdhsa_accum_offset 124
  .amdhsa_group_segment_fixed_size 0
  .amdhsa_kernarg_size 96
  .amdhsa_user_sgpr_count 2
  .amdhsa_user_sgpr_kernarg_segment_ptr 1
  .amdhsa_system_sgpr_workgroup_id_x 1
  .amdhsa_float_denorm_mode_32 3
.end_amdhsa_kernel
```
